```python
import torch

def _softmax(x, axis=-1):
    return torch.softmax(x, dim=axis)
def _gelu(x):
    return torch.nn.functional.gelu(x, approximate="tanh")
def _silu(x):
    return torch.nn.functional.silu(x)
def _sigmoid(x):
    return torch.sigmoid(x)
def _layernorm(x, axis=-1, eps=1e-5):
    m = x.mean(dim=axis, keepdim=True)
    v = x.var(dim=axis, keepdim=True, unbiased=False)
    return (x - m) / torch.sqrt(v + eps)
def _scatter_add(tgt, idx, src, axis=0):
    return tgt.clone().index_add_(axis, idx, src)
def _segment_sum(src, seg, n):
    out = torch.zeros((n,) + src.shape[1:], dtype=src.dtype)
    return out.index_add_(0, seg, src)
def _pad(x, pw):
    flat = tuple(v for pair in reversed(pw) for v in pair)
    return torch.nn.functional.pad(x, flat)

kernel_name = 'concat_heads__gqa_block_cached__gqa_block_cached__near_ridge'

def setup_inputs():

    _w = (lambda a: (lambda t: t.to(torch.bfloat16) if t.is_floating_point() else t)(torch.as_tensor(a)))
    def _A_setup():
        B, Sq, D = 16, 48, 512
        Hq, Hkv, Sk, Dh = 32, 8, 512, 128
        assert Hq % Hkv == 0, (Hq, Hkv)
        return {
            "x": _w((lambda *s: torch.randn(*s, dtype=torch.bfloat16) * 0.8)(B, Sq, D)),
            "k_cache": _w((lambda *s: torch.randn(*s, dtype=torch.bfloat16) * 0.8)(B, Hkv, Sk, Dh)),
            "v_cache": _w((lambda *s: torch.randn(*s, dtype=torch.bfloat16) * 0.05)(B, Hkv, Sk, Dh)),
            "wq": _w((lambda *s: torch.randn(*s, dtype=torch.bfloat16) * 0.8)(D, Hq * Dh) * (D ** -0.5)),
            "wo": _w((lambda *s: torch.randn(*s, dtype=torch.bfloat16) * 0.05)(Hq * Dh, D) * ((Hq * Dh) ** -0.5)),
        }
    _A_in = _A_setup()

    def _B_setup():
        B, Sq, D = 16, 48, 512
        Hq, Hkv, Sk, Dh = 32, 8, 512, 128
        assert Hq % Hkv == 0, (Hq, Hkv)
        return {
            "x": _w((lambda *s: torch.randn(*s, dtype=torch.bfloat16) * 0.8)(B, Sq, D)),
            "k_cache": _w((lambda *s: torch.randn(*s, dtype=torch.bfloat16) * 0.8)(B, Hkv, Sk, Dh)),
            "v_cache": _w((lambda *s: torch.randn(*s, dtype=torch.bfloat16) * 0.05)(B, Hkv, Sk, Dh)),
            "wq": _w((lambda *s: torch.randn(*s, dtype=torch.bfloat16) * 0.8)(D, Hq * Dh) * (D ** -0.5)),
            "wo": _w((lambda *s: torch.randn(*s, dtype=torch.bfloat16) * 0.05)(Hq * Dh, D) * ((Hq * Dh) ** -0.5)),
        }
    _B_in = _B_setup()

    return {
        "A_x": _A_in["x"],
        "A_k_cache": _A_in["k_cache"],
        "A_v_cache": _A_in["v_cache"],
        "A_wq": _A_in["wq"],
        "A_wo": _A_in["wo"],
        "B_x": _B_in["x"],
        "B_k_cache": _B_in["k_cache"],
        "B_v_cache": _B_in["v_cache"],
        "B_wq": _B_in["wq"],
        "B_wo": _B_in["wo"],
    }

def reference(A_x, A_k_cache, A_v_cache, A_wq, A_wo, B_x, B_k_cache, B_v_cache, B_wq, B_wo):
    def _A_ref(x, k_cache, v_cache, wq, wo):
        B, Sq, D = x.shape
        Hq, Dh = 32, 128
        Hkv = k_cache.shape[1]
        rep = Hq // Hkv
        q = (lambda x, *d: x.permute(*d))((x @ wq).reshape(B, Sq, Hq, Dh), 0, 2, 1, 3)
        k = (lambda x, n, axis: torch.repeat_interleave(x, n, dim=axis))(k_cache, rep, axis=1)
        v = (lambda x, n, axis: torch.repeat_interleave(x, n, dim=axis))(v_cache, rep, axis=1)
        scores = torch.einsum("bhqd,bhkd->bhqk", q, k) * (Dh ** -0.5)
        p = _softmax(scores, axis=-1)
        o = torch.einsum("bhqk,bhkd->bhqd", p, v)
        return (lambda x, *d: x.permute(*d))(o, 0, 2, 1, 3).reshape(B, Sq, Hq * Dh) @ wo

    def _B_ref(x, k_cache, v_cache, wq, wo):
        B, Sq, D = x.shape
        Hq, Dh = 32, 128
        Hkv = k_cache.shape[1]
        rep = Hq // Hkv
        q = (lambda x, *d: x.permute(*d))((x @ wq).reshape(B, Sq, Hq, Dh), 0, 2, 1, 3)
        k = (lambda x, n, axis: torch.repeat_interleave(x, n, dim=axis))(k_cache, rep, axis=1)
        v = (lambda x, n, axis: torch.repeat_interleave(x, n, dim=axis))(v_cache, rep, axis=1)
        scores = torch.einsum("bhqd,bhkd->bhqk", q, k) * (Dh ** -0.5)
        p = _softmax(scores, axis=-1)
        o = torch.einsum("bhqk,bhkd->bhqd", p, v)
        return (lambda x, *d: x.permute(*d))(o, 0, 2, 1, 3).reshape(B, Sq, Hq * Dh) @ wo

    a = _A_ref(A_x, A_k_cache, A_v_cache, A_wq, A_wo)
    b = _B_ref(B_x, B_k_cache, B_v_cache, B_wq, B_wo)
    return torch.concatenate([a, b], axis=-1)
```

```asm
; @launch kernel=concat_heads__gqa_block_cached__gqa_block_cached__near_ridge_kernel grid=(256,1,1) block=(512,1,1) lds=163840
; @launch kernel=gqa_reduce_kernel grid=(384,1,1) block=(256,1,1) lds=0
.amdgcn_target "amdgcn-amd-amdhsa--gfx950"
.text
.globl concat_heads__gqa_block_cached__gqa_block_cached__near_ridge_kernel
.p2align 8
.type concat_heads__gqa_block_cached__gqa_block_cached__near_ridge_kernel,@function
concat_heads__gqa_block_cached__gqa_block_cached__near_ridge_kernel:
    s_cmp_ge_u32 s2, 256
    s_cbranch_scc1 L_end1
    s_load_dwordx16 s[16:31], s[0:1], 0
    s_load_dwordx4 s[32:35], s[0:1], 64
    s_load_dwordx2 s[38:39], s[0:1], 96
    v_lshrrev_b32 v2, 6, v0
    v_and_b32 v1, 63, v0
    v_readfirstlane_b32 s3, v2
    s_and_b32 s4, s2, 7
    s_lshr_b32 s5, s2, 3
    s_and_b32 s5, s5, 15
    s_lshr_b32 s6, s2, 7
    v_and_b32 v2, 15, v1
    v_lshrrev_b32 v3, 4, v1
    v_lshrrev_b32 v4, 2, v1
    v_and_b32 v4, 3, v4
    v_and_b32 v5, 3, v1
    v_lshlrev_b32 v6, 4, v1
    s_lshr_b32 s7, s3, 1
    s_and_b32 s8, s7, 1
    s_waitcnt lgkmcnt(0)
    s_cmp_eq_u32 s6, 0
    s_cselect_b32 s40, s16, s26
    s_cselect_b32 s41, s17, s27
    s_cselect_b32 s60, s18, s28
    s_cselect_b32 s61, s19, s29
    s_cselect_b32 s62, s20, s30
    s_cselect_b32 s63, s21, s31
    s_cselect_b32 s44, s22, s32
    s_cselect_b32 s45, s23, s33
    s_cselect_b32 s48, s24, s34
    s_cselect_b32 s49, s25, s35
    s_mov_b32 s42, 786432
    s_mov_b32 s43, 131072
    s_mov_b32 s46, 4194304
    s_mov_b32 s47, 131072
    s_mov_b32 s50, 4194304
    s_mov_b32 s51, 131072
    s_cmp_eq_u32 s8, 0
    s_cselect_b32 s52, s60, s62
    s_cselect_b32 s53, s61, s63
    s_mov_b32 s54, 16777216
    s_mov_b32 s55, 131072
    s_mov_b32 s56, s38
    s_mov_b32 s57, s39
    s_mov_b32 s58, 25165824
    s_mov_b32 s59, 131072
    s_lshl_b32 s36, s5, 3
    s_add_u32 s36, s36, s4
    s_lshl_b32 s36, s36, 17
    s_and_b32 s37, s3, 1
    s_lshl_b32 s37, s37, 16
    s_add_u32 s37, s37, s36
    s_cmp_ge_u32 s3, 4
    s_cbranch_scc0 L_1
L_1:
    s_mul_i32 s10, s3, 8576
    s_add_u32 s10, s10, 50688
    s_lshl_b32 s11, s3, 16
    s_lshl_b32 s13, s4, 10
    s_add_u32 s11, s11, s13
    s_lshl_b32 s12, s4, 19
    s_lshl_b32 s13, s3, 13
    s_add_u32 s12, s12, s13
    s_mul_i32 s13, s3, 6
    v_lshrrev_b32 v101, 2, v1
    v_add_u32 v101, s13, v101
    v_lshrrev_b32 v100, 2, v101
    v_sub_u32 v100, 0, v100
    v_and_b32 v100, 3, v100
    v_xor_b32 v100, v100, v5
    v_lshlrev_b32 v100, 4, v100
    v_lshlrev_b32 v101, 10, v101
    v_add_u32 v100, v100, v101
    s_mul_i32 s15, s5, 49152
    s_mul_i32 s63, s3, 384
    s_mul_i32 s10, s3, 4224
    s_lshr_b32 s13, s3, 1
    s_lshl_b32 s13, s13, 7
    s_add_u32 s10, s10, s13
    s_lshl_b32 s11, s3, 15
    s_lshl_b32 s13, s4, 10
    s_add_u32 s11, s11, s13
    s_add_u32 s60, s5, 0
    s_and_b32 s60, s60, 15
    s_lshl_b32 s61, s60, 6
    s_mul_i32 s60, s60, 262144
    s_add_u32 s60, s60, s11
    s_add_u32 m0, s63, 71680
    s_add_u32 s14, s15, s61
    s_mov_b64 exec, 0xffffff
    buffer_load_dwordx4 v100, s[40:43], s14 offen lds
    s_mov_b64 exec, -1
    s_add_u32 m0, s10, 37376
    s_add_u32 s14, s60, 0
    buffer_load_dwordx4 v6, s[44:47], s14 offen lds
    s_add_u32 m0, s10, 38432
    s_add_u32 s14, s60, 8192
    buffer_load_dwordx4 v6, s[44:47], s14 offen lds
    s_add_u32 m0, s10, 39488
    s_add_u32 s14, s60, 16384
    buffer_load_dwordx4 v6, s[44:47], s14 offen lds
    s_add_u32 m0, s10, 40544
    s_add_u32 s14, s60, 24576
    buffer_load_dwordx4 v6, s[44:47], s14 offen lds
    s_add_u32 s60, s5, 1
    s_and_b32 s60, s60, 15
    s_lshl_b32 s61, s60, 6
    s_mul_i32 s60, s60, 262144
    s_add_u32 s60, s60, s11
    s_add_u32 m0, s63, 109056
    s_add_u32 s14, s15, s61
    s_mov_b64 exec, 0xffffff
    buffer_load_dwordx4 v100, s[40:43], s14 offen lds
    s_mov_b64 exec, -1
    s_add_u32 m0, s10, 74752
    s_add_u32 s14, s60, 0
    buffer_load_dwordx4 v6, s[44:47], s14 offen lds
    s_add_u32 m0, s10, 75808
    s_add_u32 s14, s60, 8192
    buffer_load_dwordx4 v6, s[44:47], s14 offen lds
    s_add_u32 m0, s10, 76864
    s_add_u32 s14, s60, 16384
    buffer_load_dwordx4 v6, s[44:47], s14 offen lds
    s_add_u32 m0, s10, 77920
    s_add_u32 s14, s60, 24576
    buffer_load_dwordx4 v6, s[44:47], s14 offen lds
    s_add_u32 s60, s5, 2
    s_and_b32 s60, s60, 15
    s_lshl_b32 s61, s60, 6
    s_mul_i32 s60, s60, 262144
    s_add_u32 s60, s60, s11
    s_add_u32 m0, s63, 146432
    s_add_u32 s14, s15, s61
    s_mov_b64 exec, 0xffffff
    buffer_load_dwordx4 v100, s[40:43], s14 offen lds
    s_mov_b64 exec, -1
    s_add_u32 m0, s10, 112128
    s_add_u32 s14, s60, 0
    buffer_load_dwordx4 v6, s[44:47], s14 offen lds
    s_add_u32 m0, s10, 113184
    s_add_u32 s14, s60, 8192
    buffer_load_dwordx4 v6, s[44:47], s14 offen lds
    s_add_u32 m0, s10, 114240
    s_add_u32 s14, s60, 16384
    buffer_load_dwordx4 v6, s[44:47], s14 offen lds
    s_add_u32 m0, s10, 115296
    s_add_u32 s14, s60, 24576
    buffer_load_dwordx4 v6, s[44:47], s14 offen lds
    v_lshlrev_b32 v7, 3, v3
    v_add_u32 v7, v7, v4
    v_mul_u32_u24 v7, 1056, v7
    v_lshlrev_b32 v8, 7, v3
    v_add_u32 v7, v7, v8
    v_lshlrev_b32 v8, 3, v5
    v_add_u32 v7, v7, v8
    s_lshl_b32 s9, s3, 7
    s_add_u32 s9, s9, 50688
    v_add_u32 v8, s9, v7
    v_add_u32 v9, 34304, v8
    v_add_u32 v10, 68608, v8
    v_mul_u32_u24 v11, 1056, v2
    v_lshlrev_b32 v12, 4, v3
    v_add_u32 v11, v11, v12
    v_add_u32 v92, -50688, v8
    v_add_u32 v93, -13312, v8
    v_add_u32 v94, 24064, v8
    v_add_u32 v95, 61440, v8
    v_lshrrev_b32 v12, 2, v2
    v_sub_u32 v12, 0, v12
    v_and_b32 v12, 3, v12
    v_xor_b32 v12, v12, v3
    v_lshlrev_b32 v12, 4, v12
    v_lshlrev_b32 v13, 6, v2
    v_add_u32 v12, v12, v13
    v_add_u32 v96, 34304, v12
    v_add_u32 v97, 71680, v12
    v_add_u32 v98, 109056, v12
    v_add_u32 v99, 146432, v12
    s_waitcnt vmcnt(10)
    s_barrier
    ds_read_b128 v[80:83], v97
    ds_read_b128 v[84:87], v97 offset:1024
    ds_read_b128 v[88:91], v97 offset:2048
    ds_read_b64_tr_b16 v[64:65], v93
    ds_read_b64_tr_b16 v[66:67], v93 offset:4224
    ds_read_b64_tr_b16 v[68:69], v93 offset:32
    ds_read_b64_tr_b16 v[70:71], v93 offset:4256
    ds_read_b64_tr_b16 v[72:73], v93 offset:64
    ds_read_b64_tr_b16 v[74:75], v93 offset:4288
    ds_read_b64_tr_b16 v[76:77], v93 offset:96
    ds_read_b64_tr_b16 v[78:79], v93 offset:4320
    s_add_u32 s60, s5, 3
    s_and_b32 s60, s60, 15
    s_lshl_b32 s61, s60, 6
    s_mul_i32 s60, s60, 262144
    s_add_u32 s60, s60, s11
    s_add_u32 m0, s63, 34304
    s_add_u32 s14, s15, s61
    s_mov_b64 exec, 0xffffff
    buffer_load_dwordx4 v100, s[40:43], s14 offen lds
    s_mov_b64 exec, -1
    s_add_u32 m0, s10, 0
    s_add_u32 s14, s60, 0
    buffer_load_dwordx4 v6, s[44:47], s14 offen lds
    s_waitcnt lgkmcnt(6)
    v_mfma_f32_16x16x32_bf16 v[16:19], v[64:67], v[80:83], 0
    v_mfma_f32_16x16x32_bf16 v[20:23], v[64:67], v[84:87], 0
    v_mfma_f32_16x16x32_bf16 v[24:27], v[64:67], v[88:91], 0
    s_add_u32 m0, s10, 1056
    s_add_u32 s14, s60, 8192
    buffer_load_dwordx4 v6, s[44:47], s14 offen lds
    s_waitcnt lgkmcnt(4)
    v_mfma_f32_16x16x32_bf16 v[28:31], v[68:71], v[80:83], 0
    v_mfma_f32_16x16x32_bf16 v[32:35], v[68:71], v[84:87], 0
    v_mfma_f32_16x16x32_bf16 v[36:39], v[68:71], v[88:91], 0
    s_add_u32 m0, s10, 2112
    s_add_u32 s14, s60, 16384
    buffer_load_dwordx4 v6, s[44:47], s14 offen lds
    s_waitcnt lgkmcnt(2)
    v_mfma_f32_16x16x32_bf16 v[40:43], v[72:75], v[80:83], 0
    v_mfma_f32_16x16x32_bf16 v[44:47], v[72:75], v[84:87], 0
    v_mfma_f32_16x16x32_bf16 v[48:51], v[72:75], v[88:91], 0
    s_add_u32 m0, s10, 3168
    s_add_u32 s14, s60, 24576
    buffer_load_dwordx4 v6, s[44:47], s14 offen lds
    s_waitcnt lgkmcnt(0)
    v_mfma_f32_16x16x32_bf16 v[52:55], v[76:79], v[80:83], 0
    v_mfma_f32_16x16x32_bf16 v[56:59], v[76:79], v[84:87], 0
    v_mfma_f32_16x16x32_bf16 v[60:63], v[76:79], v[88:91], 0
    s_waitcnt vmcnt(10)
    s_barrier
    ds_read_b128 v[80:83], v98
    ds_read_b128 v[84:87], v98 offset:1024
    ds_read_b128 v[88:91], v98 offset:2048
    ds_read_b64_tr_b16 v[64:65], v94
    ds_read_b64_tr_b16 v[66:67], v94 offset:4224
    ds_read_b64_tr_b16 v[68:69], v94 offset:32
    ds_read_b64_tr_b16 v[70:71], v94 offset:4256
    ds_read_b64_tr_b16 v[72:73], v94 offset:64
    ds_read_b64_tr_b16 v[74:75], v94 offset:4288
    ds_read_b64_tr_b16 v[76:77], v94 offset:96
    ds_read_b64_tr_b16 v[78:79], v94 offset:4320
    s_add_u32 s60, s5, 4
    s_and_b32 s60, s60, 15
    s_lshl_b32 s61, s60, 6
    s_mul_i32 s60, s60, 262144
    s_add_u32 s60, s60, s11
    s_add_u32 m0, s63, 71680
    s_add_u32 s14, s15, s61
    s_mov_b64 exec, 0xffffff
    buffer_load_dwordx4 v100, s[40:43], s14 offen lds
    s_mov_b64 exec, -1
    s_add_u32 m0, s10, 37376
    s_add_u32 s14, s60, 0
    buffer_load_dwordx4 v6, s[44:47], s14 offen lds
    s_waitcnt lgkmcnt(6)
    v_mfma_f32_16x16x32_bf16 v[16:19], v[64:67], v[80:83], v[16:19]
    v_mfma_f32_16x16x32_bf16 v[20:23], v[64:67], v[84:87], v[20:23]
    v_mfma_f32_16x16x32_bf16 v[24:27], v[64:67], v[88:91], v[24:27]
    s_add_u32 m0, s10, 38432
    s_add_u32 s14, s60, 8192
    buffer_load_dwordx4 v6, s[44:47], s14 offen lds
    s_waitcnt lgkmcnt(4)
    v_mfma_f32_16x16x32_bf16 v[28:31], v[68:71], v[80:83], v[28:31]
    v_mfma_f32_16x16x32_bf16 v[32:35], v[68:71], v[84:87], v[32:35]
    v_mfma_f32_16x16x32_bf16 v[36:39], v[68:71], v[88:91], v[36:39]
    s_add_u32 m0, s10, 39488
    s_add_u32 s14, s60, 16384
    buffer_load_dwordx4 v6, s[44:47], s14 offen lds
    s_waitcnt lgkmcnt(2)
    v_mfma_f32_16x16x32_bf16 v[40:43], v[72:75], v[80:83], v[40:43]
    v_mfma_f32_16x16x32_bf16 v[44:47], v[72:75], v[84:87], v[44:47]
    v_mfma_f32_16x16x32_bf16 v[48:51], v[72:75], v[88:91], v[48:51]
    s_add_u32 m0, s10, 40544
    s_add_u32 s14, s60, 24576
    buffer_load_dwordx4 v6, s[44:47], s14 offen lds
    s_waitcnt lgkmcnt(0)
    v_mfma_f32_16x16x32_bf16 v[52:55], v[76:79], v[80:83], v[52:55]
    v_mfma_f32_16x16x32_bf16 v[56:59], v[76:79], v[84:87], v[56:59]
    v_mfma_f32_16x16x32_bf16 v[60:63], v[76:79], v[88:91], v[60:63]
    s_waitcnt vmcnt(10)
    s_barrier
    ds_read_b128 v[80:83], v99
    ds_read_b128 v[84:87], v99 offset:1024
    ds_read_b128 v[88:91], v99 offset:2048
    ds_read_b64_tr_b16 v[64:65], v95
    ds_read_b64_tr_b16 v[66:67], v95 offset:4224
    ds_read_b64_tr_b16 v[68:69], v95 offset:32
    ds_read_b64_tr_b16 v[70:71], v95 offset:4256
    ds_read_b64_tr_b16 v[72:73], v95 offset:64
    ds_read_b64_tr_b16 v[74:75], v95 offset:4288
    ds_read_b64_tr_b16 v[76:77], v95 offset:96
    ds_read_b64_tr_b16 v[78:79], v95 offset:4320
    s_add_u32 s60, s5, 5
    s_and_b32 s60, s60, 15
    s_lshl_b32 s61, s60, 6
    s_mul_i32 s60, s60, 262144
    s_add_u32 s60, s60, s11
    s_add_u32 m0, s63, 109056
    s_add_u32 s14, s15, s61
    s_mov_b64 exec, 0xffffff
    buffer_load_dwordx4 v100, s[40:43], s14 offen lds
    s_mov_b64 exec, -1
    s_add_u32 m0, s10, 74752
    s_add_u32 s14, s60, 0
    buffer_load_dwordx4 v6, s[44:47], s14 offen lds
    s_waitcnt lgkmcnt(6)
    v_mfma_f32_16x16x32_bf16 v[16:19], v[64:67], v[80:83], v[16:19]
    v_mfma_f32_16x16x32_bf16 v[20:23], v[64:67], v[84:87], v[20:23]
    v_mfma_f32_16x16x32_bf16 v[24:27], v[64:67], v[88:91], v[24:27]
    s_add_u32 m0, s10, 75808
    s_add_u32 s14, s60, 8192
    buffer_load_dwordx4 v6, s[44:47], s14 offen lds
    s_waitcnt lgkmcnt(4)
    v_mfma_f32_16x16x32_bf16 v[28:31], v[68:71], v[80:83], v[28:31]
    v_mfma_f32_16x16x32_bf16 v[32:35], v[68:71], v[84:87], v[32:35]
    v_mfma_f32_16x16x32_bf16 v[36:39], v[68:71], v[88:91], v[36:39]
    s_add_u32 m0, s10, 76864
    s_add_u32 s14, s60, 16384
    buffer_load_dwordx4 v6, s[44:47], s14 offen lds
    s_waitcnt lgkmcnt(2)
    v_mfma_f32_16x16x32_bf16 v[40:43], v[72:75], v[80:83], v[40:43]
    v_mfma_f32_16x16x32_bf16 v[44:47], v[72:75], v[84:87], v[44:47]
    v_mfma_f32_16x16x32_bf16 v[48:51], v[72:75], v[88:91], v[48:51]
    s_add_u32 m0, s10, 77920
    s_add_u32 s14, s60, 24576
    buffer_load_dwordx4 v6, s[44:47], s14 offen lds
    s_waitcnt lgkmcnt(0)
    v_mfma_f32_16x16x32_bf16 v[52:55], v[76:79], v[80:83], v[52:55]
    v_mfma_f32_16x16x32_bf16 v[56:59], v[76:79], v[84:87], v[56:59]
    v_mfma_f32_16x16x32_bf16 v[60:63], v[76:79], v[88:91], v[60:63]
    s_waitcnt vmcnt(10)
    s_barrier
    ds_read_b128 v[80:83], v96
    ds_read_b128 v[84:87], v96 offset:1024
    ds_read_b128 v[88:91], v96 offset:2048
    ds_read_b64_tr_b16 v[64:65], v92
    ds_read_b64_tr_b16 v[66:67], v92 offset:4224
    ds_read_b64_tr_b16 v[68:69], v92 offset:32
    ds_read_b64_tr_b16 v[70:71], v92 offset:4256
    ds_read_b64_tr_b16 v[72:73], v92 offset:64
    ds_read_b64_tr_b16 v[74:75], v92 offset:4288
    ds_read_b64_tr_b16 v[76:77], v92 offset:96
    ds_read_b64_tr_b16 v[78:79], v92 offset:4320
    s_add_u32 s60, s5, 6
    s_and_b32 s60, s60, 15
    s_lshl_b32 s61, s60, 6
    s_mul_i32 s60, s60, 262144
    s_add_u32 s60, s60, s11
    s_add_u32 m0, s63, 146432
    s_add_u32 s14, s15, s61
    s_mov_b64 exec, 0xffffff
    buffer_load_dwordx4 v100, s[40:43], s14 offen lds
    s_mov_b64 exec, -1
    s_add_u32 m0, s10, 112128
    s_add_u32 s14, s60, 0
    buffer_load_dwordx4 v6, s[44:47], s14 offen lds
    s_waitcnt lgkmcnt(6)
    v_mfma_f32_16x16x32_bf16 v[16:19], v[64:67], v[80:83], v[16:19]
    v_mfma_f32_16x16x32_bf16 v[20:23], v[64:67], v[84:87], v[20:23]
    v_mfma_f32_16x16x32_bf16 v[24:27], v[64:67], v[88:91], v[24:27]
    s_add_u32 m0, s10, 113184
    s_add_u32 s14, s60, 8192
    buffer_load_dwordx4 v6, s[44:47], s14 offen lds
    s_waitcnt lgkmcnt(4)
    v_mfma_f32_16x16x32_bf16 v[28:31], v[68:71], v[80:83], v[28:31]
    v_mfma_f32_16x16x32_bf16 v[32:35], v[68:71], v[84:87], v[32:35]
    v_mfma_f32_16x16x32_bf16 v[36:39], v[68:71], v[88:91], v[36:39]
    s_add_u32 m0, s10, 114240
    s_add_u32 s14, s60, 16384
    buffer_load_dwordx4 v6, s[44:47], s14 offen lds
    s_waitcnt lgkmcnt(2)
    v_mfma_f32_16x16x32_bf16 v[40:43], v[72:75], v[80:83], v[40:43]
    v_mfma_f32_16x16x32_bf16 v[44:47], v[72:75], v[84:87], v[44:47]
    v_mfma_f32_16x16x32_bf16 v[48:51], v[72:75], v[88:91], v[48:51]
    s_add_u32 m0, s10, 115296
    s_add_u32 s14, s60, 24576
    buffer_load_dwordx4 v6, s[44:47], s14 offen lds
    s_waitcnt lgkmcnt(0)
    v_mfma_f32_16x16x32_bf16 v[52:55], v[76:79], v[80:83], v[52:55]
    v_mfma_f32_16x16x32_bf16 v[56:59], v[76:79], v[84:87], v[56:59]
    v_mfma_f32_16x16x32_bf16 v[60:63], v[76:79], v[88:91], v[60:63]
    s_waitcnt vmcnt(10)
    s_barrier
    ds_read_b128 v[80:83], v97
    ds_read_b128 v[84:87], v97 offset:1024
    ds_read_b128 v[88:91], v97 offset:2048
    ds_read_b64_tr_b16 v[64:65], v93
    ds_read_b64_tr_b16 v[66:67], v93 offset:4224
    ds_read_b64_tr_b16 v[68:69], v93 offset:32
    ds_read_b64_tr_b16 v[70:71], v93 offset:4256
    ds_read_b64_tr_b16 v[72:73], v93 offset:64
    ds_read_b64_tr_b16 v[74:75], v93 offset:4288
    ds_read_b64_tr_b16 v[76:77], v93 offset:96
    ds_read_b64_tr_b16 v[78:79], v93 offset:4320
    s_add_u32 s60, s5, 7
    s_and_b32 s60, s60, 15
    s_lshl_b32 s61, s60, 6
    s_mul_i32 s60, s60, 262144
    s_add_u32 s60, s60, s11
    s_add_u32 m0, s63, 34304
    s_add_u32 s14, s15, s61
    s_mov_b64 exec, 0xffffff
    buffer_load_dwordx4 v100, s[40:43], s14 offen lds
    s_mov_b64 exec, -1
    s_add_u32 m0, s10, 0
    s_add_u32 s14, s60, 0
    buffer_load_dwordx4 v6, s[44:47], s14 offen lds
    s_waitcnt lgkmcnt(6)
    v_mfma_f32_16x16x32_bf16 v[16:19], v[64:67], v[80:83], v[16:19]
    v_mfma_f32_16x16x32_bf16 v[20:23], v[64:67], v[84:87], v[20:23]
    v_mfma_f32_16x16x32_bf16 v[24:27], v[64:67], v[88:91], v[24:27]
    s_add_u32 m0, s10, 1056
    s_add_u32 s14, s60, 8192
    buffer_load_dwordx4 v6, s[44:47], s14 offen lds
    s_waitcnt lgkmcnt(4)
    v_mfma_f32_16x16x32_bf16 v[28:31], v[68:71], v[80:83], v[28:31]
    v_mfma_f32_16x16x32_bf16 v[32:35], v[68:71], v[84:87], v[32:35]
    v_mfma_f32_16x16x32_bf16 v[36:39], v[68:71], v[88:91], v[36:39]
    s_add_u32 m0, s10, 2112
    s_add_u32 s14, s60, 16384
    buffer_load_dwordx4 v6, s[44:47], s14 offen lds
    s_waitcnt lgkmcnt(2)
    v_mfma_f32_16x16x32_bf16 v[40:43], v[72:75], v[80:83], v[40:43]
    v_mfma_f32_16x16x32_bf16 v[44:47], v[72:75], v[84:87], v[44:47]
    v_mfma_f32_16x16x32_bf16 v[48:51], v[72:75], v[88:91], v[48:51]
    s_add_u32 m0, s10, 3168
    s_add_u32 s14, s60, 24576
    buffer_load_dwordx4 v6, s[44:47], s14 offen lds
    s_waitcnt lgkmcnt(0)
    v_mfma_f32_16x16x32_bf16 v[52:55], v[76:79], v[80:83], v[52:55]
    v_mfma_f32_16x16x32_bf16 v[56:59], v[76:79], v[84:87], v[56:59]
    v_mfma_f32_16x16x32_bf16 v[60:63], v[76:79], v[88:91], v[60:63]
    s_waitcnt vmcnt(10)
    s_barrier
    ds_read_b128 v[80:83], v98
    ds_read_b128 v[84:87], v98 offset:1024
    ds_read_b128 v[88:91], v98 offset:2048
    ds_read_b64_tr_b16 v[64:65], v94
    ds_read_b64_tr_b16 v[66:67], v94 offset:4224
    ds_read_b64_tr_b16 v[68:69], v94 offset:32
    ds_read_b64_tr_b16 v[70:71], v94 offset:4256
    ds_read_b64_tr_b16 v[72:73], v94 offset:64
    ds_read_b64_tr_b16 v[74:75], v94 offset:4288
    ds_read_b64_tr_b16 v[76:77], v94 offset:96
    ds_read_b64_tr_b16 v[78:79], v94 offset:4320
    s_add_u32 s60, s5, 8
    s_and_b32 s60, s60, 15
    s_lshl_b32 s61, s60, 6
    s_mul_i32 s60, s60, 262144
    s_add_u32 s60, s60, s11
    s_add_u32 m0, s63, 71680
    s_add_u32 s14, s15, s61
    s_mov_b64 exec, 0xffffff
    buffer_load_dwordx4 v100, s[40:43], s14 offen lds
    s_mov_b64 exec, -1
    s_add_u32 m0, s10, 37376
    s_add_u32 s14, s60, 0
    buffer_load_dwordx4 v6, s[44:47], s14 offen lds
    s_waitcnt lgkmcnt(6)
    v_mfma_f32_16x16x32_bf16 v[16:19], v[64:67], v[80:83], v[16:19]
    v_mfma_f32_16x16x32_bf16 v[20:23], v[64:67], v[84:87], v[20:23]
    v_mfma_f32_16x16x32_bf16 v[24:27], v[64:67], v[88:91], v[24:27]
    s_add_u32 m0, s10, 38432
    s_add_u32 s14, s60, 8192
    buffer_load_dwordx4 v6, s[44:47], s14 offen lds
    s_waitcnt lgkmcnt(4)
    v_mfma_f32_16x16x32_bf16 v[28:31], v[68:71], v[80:83], v[28:31]
    v_mfma_f32_16x16x32_bf16 v[32:35], v[68:71], v[84:87], v[32:35]
    v_mfma_f32_16x16x32_bf16 v[36:39], v[68:71], v[88:91], v[36:39]
    s_add_u32 m0, s10, 39488
    s_add_u32 s14, s60, 16384
    buffer_load_dwordx4 v6, s[44:47], s14 offen lds
    s_waitcnt lgkmcnt(2)
    v_mfma_f32_16x16x32_bf16 v[40:43], v[72:75], v[80:83], v[40:43]
    v_mfma_f32_16x16x32_bf16 v[44:47], v[72:75], v[84:87], v[44:47]
    v_mfma_f32_16x16x32_bf16 v[48:51], v[72:75], v[88:91], v[48:51]
    s_add_u32 m0, s10, 40544
    s_add_u32 s14, s60, 24576
    buffer_load_dwordx4 v6, s[44:47], s14 offen lds
    s_waitcnt lgkmcnt(0)
    v_mfma_f32_16x16x32_bf16 v[52:55], v[76:79], v[80:83], v[52:55]
    v_mfma_f32_16x16x32_bf16 v[56:59], v[76:79], v[84:87], v[56:59]
    v_mfma_f32_16x16x32_bf16 v[60:63], v[76:79], v[88:91], v[60:63]
    s_waitcnt vmcnt(10)
    s_barrier
    ds_read_b128 v[80:83], v99
    ds_read_b128 v[84:87], v99 offset:1024
    ds_read_b128 v[88:91], v99 offset:2048
    ds_read_b64_tr_b16 v[64:65], v95
    ds_read_b64_tr_b16 v[66:67], v95 offset:4224
    ds_read_b64_tr_b16 v[68:69], v95 offset:32
    ds_read_b64_tr_b16 v[70:71], v95 offset:4256
    ds_read_b64_tr_b16 v[72:73], v95 offset:64
    ds_read_b64_tr_b16 v[74:75], v95 offset:4288
    ds_read_b64_tr_b16 v[76:77], v95 offset:96
    ds_read_b64_tr_b16 v[78:79], v95 offset:4320
    s_add_u32 s60, s5, 9
    s_and_b32 s60, s60, 15
    s_lshl_b32 s61, s60, 6
    s_mul_i32 s60, s60, 262144
    s_add_u32 s60, s60, s11
    s_add_u32 m0, s63, 109056
    s_add_u32 s14, s15, s61
    s_mov_b64 exec, 0xffffff
    buffer_load_dwordx4 v100, s[40:43], s14 offen lds
    s_mov_b64 exec, -1
    s_add_u32 m0, s10, 74752
    s_add_u32 s14, s60, 0
    buffer_load_dwordx4 v6, s[44:47], s14 offen lds
    s_waitcnt lgkmcnt(6)
    v_mfma_f32_16x16x32_bf16 v[16:19], v[64:67], v[80:83], v[16:19]
    v_mfma_f32_16x16x32_bf16 v[20:23], v[64:67], v[84:87], v[20:23]
    v_mfma_f32_16x16x32_bf16 v[24:27], v[64:67], v[88:91], v[24:27]
    s_add_u32 m0, s10, 75808
    s_add_u32 s14, s60, 8192
    buffer_load_dwordx4 v6, s[44:47], s14 offen lds
    s_waitcnt lgkmcnt(4)
    v_mfma_f32_16x16x32_bf16 v[28:31], v[68:71], v[80:83], v[28:31]
    v_mfma_f32_16x16x32_bf16 v[32:35], v[68:71], v[84:87], v[32:35]
    v_mfma_f32_16x16x32_bf16 v[36:39], v[68:71], v[88:91], v[36:39]
    s_add_u32 m0, s10, 76864
    s_add_u32 s14, s60, 16384
    buffer_load_dwordx4 v6, s[44:47], s14 offen lds
    s_waitcnt lgkmcnt(2)
    v_mfma_f32_16x16x32_bf16 v[40:43], v[72:75], v[80:83], v[40:43]
    v_mfma_f32_16x16x32_bf16 v[44:47], v[72:75], v[84:87], v[44:47]
    v_mfma_f32_16x16x32_bf16 v[48:51], v[72:75], v[88:91], v[48:51]
    s_add_u32 m0, s10, 77920
    s_add_u32 s14, s60, 24576
    buffer_load_dwordx4 v6, s[44:47], s14 offen lds
    s_waitcnt lgkmcnt(0)
    v_mfma_f32_16x16x32_bf16 v[52:55], v[76:79], v[80:83], v[52:55]
    v_mfma_f32_16x16x32_bf16 v[56:59], v[76:79], v[84:87], v[56:59]
    v_mfma_f32_16x16x32_bf16 v[60:63], v[76:79], v[88:91], v[60:63]
    s_waitcnt vmcnt(10)
    s_barrier
    ds_read_b128 v[80:83], v96
    ds_read_b128 v[84:87], v96 offset:1024
    ds_read_b128 v[88:91], v96 offset:2048
    ds_read_b64_tr_b16 v[64:65], v92
    ds_read_b64_tr_b16 v[66:67], v92 offset:4224
    ds_read_b64_tr_b16 v[68:69], v92 offset:32
    ds_read_b64_tr_b16 v[70:71], v92 offset:4256
    ds_read_b64_tr_b16 v[72:73], v92 offset:64
    ds_read_b64_tr_b16 v[74:75], v92 offset:4288
    ds_read_b64_tr_b16 v[76:77], v92 offset:96
    ds_read_b64_tr_b16 v[78:79], v92 offset:4320
    s_add_u32 s60, s5, 10
    s_and_b32 s60, s60, 15
    s_lshl_b32 s61, s60, 6
    s_mul_i32 s60, s60, 262144
    s_add_u32 s60, s60, s11
    s_add_u32 m0, s63, 146432
    s_add_u32 s14, s15, s61
    s_mov_b64 exec, 0xffffff
    buffer_load_dwordx4 v100, s[40:43], s14 offen lds
    s_mov_b64 exec, -1
    s_add_u32 m0, s10, 112128
    s_add_u32 s14, s60, 0
    buffer_load_dwordx4 v6, s[44:47], s14 offen lds
    s_waitcnt lgkmcnt(6)
    v_mfma_f32_16x16x32_bf16 v[16:19], v[64:67], v[80:83], v[16:19]
    v_mfma_f32_16x16x32_bf16 v[20:23], v[64:67], v[84:87], v[20:23]
    v_mfma_f32_16x16x32_bf16 v[24:27], v[64:67], v[88:91], v[24:27]
    s_add_u32 m0, s10, 113184
    s_add_u32 s14, s60, 8192
    buffer_load_dwordx4 v6, s[44:47], s14 offen lds
    s_waitcnt lgkmcnt(4)
    v_mfma_f32_16x16x32_bf16 v[28:31], v[68:71], v[80:83], v[28:31]
    v_mfma_f32_16x16x32_bf16 v[32:35], v[68:71], v[84:87], v[32:35]
    v_mfma_f32_16x16x32_bf16 v[36:39], v[68:71], v[88:91], v[36:39]
    s_add_u32 m0, s10, 114240
    s_add_u32 s14, s60, 16384
    buffer_load_dwordx4 v6, s[44:47], s14 offen lds
    s_waitcnt lgkmcnt(2)
    v_mfma_f32_16x16x32_bf16 v[40:43], v[72:75], v[80:83], v[40:43]
    v_mfma_f32_16x16x32_bf16 v[44:47], v[72:75], v[84:87], v[44:47]
    v_mfma_f32_16x16x32_bf16 v[48:51], v[72:75], v[88:91], v[48:51]
    s_add_u32 m0, s10, 115296
    s_add_u32 s14, s60, 24576
    buffer_load_dwordx4 v6, s[44:47], s14 offen lds
    s_waitcnt lgkmcnt(0)
    v_mfma_f32_16x16x32_bf16 v[52:55], v[76:79], v[80:83], v[52:55]
    v_mfma_f32_16x16x32_bf16 v[56:59], v[76:79], v[84:87], v[56:59]
    v_mfma_f32_16x16x32_bf16 v[60:63], v[76:79], v[88:91], v[60:63]
    s_waitcnt vmcnt(10)
    s_barrier
    ds_read_b128 v[80:83], v97
    ds_read_b128 v[84:87], v97 offset:1024
    ds_read_b128 v[88:91], v97 offset:2048
    ds_read_b64_tr_b16 v[64:65], v93
    ds_read_b64_tr_b16 v[66:67], v93 offset:4224
    ds_read_b64_tr_b16 v[68:69], v93 offset:32
    ds_read_b64_tr_b16 v[70:71], v93 offset:4256
    ds_read_b64_tr_b16 v[72:73], v93 offset:64
    ds_read_b64_tr_b16 v[74:75], v93 offset:4288
    ds_read_b64_tr_b16 v[76:77], v93 offset:96
    ds_read_b64_tr_b16 v[78:79], v93 offset:4320
    s_add_u32 s60, s5, 11
    s_and_b32 s60, s60, 15
    s_lshl_b32 s61, s60, 6
    s_mul_i32 s60, s60, 262144
    s_add_u32 s60, s60, s11
    s_add_u32 m0, s63, 34304
    s_add_u32 s14, s15, s61
    s_mov_b64 exec, 0xffffff
    buffer_load_dwordx4 v100, s[40:43], s14 offen lds
    s_mov_b64 exec, -1
    s_add_u32 m0, s10, 0
    s_add_u32 s14, s60, 0
    buffer_load_dwordx4 v6, s[44:47], s14 offen lds
    s_waitcnt lgkmcnt(6)
    v_mfma_f32_16x16x32_bf16 v[16:19], v[64:67], v[80:83], v[16:19]
    v_mfma_f32_16x16x32_bf16 v[20:23], v[64:67], v[84:87], v[20:23]
    v_mfma_f32_16x16x32_bf16 v[24:27], v[64:67], v[88:91], v[24:27]
    s_add_u32 m0, s10, 1056
    s_add_u32 s14, s60, 8192
    buffer_load_dwordx4 v6, s[44:47], s14 offen lds
    s_waitcnt lgkmcnt(4)
    v_mfma_f32_16x16x32_bf16 v[28:31], v[68:71], v[80:83], v[28:31]
    v_mfma_f32_16x16x32_bf16 v[32:35], v[68:71], v[84:87], v[32:35]
    v_mfma_f32_16x16x32_bf16 v[36:39], v[68:71], v[88:91], v[36:39]
    s_add_u32 m0, s10, 2112
    s_add_u32 s14, s60, 16384
    buffer_load_dwordx4 v6, s[44:47], s14 offen lds
    s_waitcnt lgkmcnt(2)
    v_mfma_f32_16x16x32_bf16 v[40:43], v[72:75], v[80:83], v[40:43]
    v_mfma_f32_16x16x32_bf16 v[44:47], v[72:75], v[84:87], v[44:47]
    v_mfma_f32_16x16x32_bf16 v[48:51], v[72:75], v[88:91], v[48:51]
    s_add_u32 m0, s10, 3168
    s_add_u32 s14, s60, 24576
    buffer_load_dwordx4 v6, s[44:47], s14 offen lds
    s_waitcnt lgkmcnt(0)
    v_mfma_f32_16x16x32_bf16 v[52:55], v[76:79], v[80:83], v[52:55]
    v_mfma_f32_16x16x32_bf16 v[56:59], v[76:79], v[84:87], v[56:59]
    v_mfma_f32_16x16x32_bf16 v[60:63], v[76:79], v[88:91], v[60:63]
    s_waitcnt vmcnt(10)
    s_barrier
    ds_read_b128 v[80:83], v98
    ds_read_b128 v[84:87], v98 offset:1024
    ds_read_b128 v[88:91], v98 offset:2048
    ds_read_b64_tr_b16 v[64:65], v94
    ds_read_b64_tr_b16 v[66:67], v94 offset:4224
    ds_read_b64_tr_b16 v[68:69], v94 offset:32
    ds_read_b64_tr_b16 v[70:71], v94 offset:4256
    ds_read_b64_tr_b16 v[72:73], v94 offset:64
    ds_read_b64_tr_b16 v[74:75], v94 offset:4288
    ds_read_b64_tr_b16 v[76:77], v94 offset:96
    ds_read_b64_tr_b16 v[78:79], v94 offset:4320
    s_add_u32 s60, s5, 12
    s_and_b32 s60, s60, 15
    s_lshl_b32 s61, s60, 6
    s_mul_i32 s60, s60, 262144
    s_add_u32 s60, s60, s11
    s_add_u32 m0, s63, 71680
    s_add_u32 s14, s15, s61
    s_mov_b64 exec, 0xffffff
    buffer_load_dwordx4 v100, s[40:43], s14 offen lds
    s_mov_b64 exec, -1
    s_add_u32 m0, s10, 37376
    s_add_u32 s14, s60, 0
    buffer_load_dwordx4 v6, s[44:47], s14 offen lds
    s_waitcnt lgkmcnt(6)
    v_mfma_f32_16x16x32_bf16 v[16:19], v[64:67], v[80:83], v[16:19]
    v_mfma_f32_16x16x32_bf16 v[20:23], v[64:67], v[84:87], v[20:23]
    v_mfma_f32_16x16x32_bf16 v[24:27], v[64:67], v[88:91], v[24:27]
    s_add_u32 m0, s10, 38432
    s_add_u32 s14, s60, 8192
    buffer_load_dwordx4 v6, s[44:47], s14 offen lds
    s_waitcnt lgkmcnt(4)
    v_mfma_f32_16x16x32_bf16 v[28:31], v[68:71], v[80:83], v[28:31]
    v_mfma_f32_16x16x32_bf16 v[32:35], v[68:71], v[84:87], v[32:35]
    v_mfma_f32_16x16x32_bf16 v[36:39], v[68:71], v[88:91], v[36:39]
    s_add_u32 m0, s10, 39488
    s_add_u32 s14, s60, 16384
    buffer_load_dwordx4 v6, s[44:47], s14 offen lds
    s_waitcnt lgkmcnt(2)
    v_mfma_f32_16x16x32_bf16 v[40:43], v[72:75], v[80:83], v[40:43]
    v_mfma_f32_16x16x32_bf16 v[44:47], v[72:75], v[84:87], v[44:47]
    v_mfma_f32_16x16x32_bf16 v[48:51], v[72:75], v[88:91], v[48:51]
    s_add_u32 m0, s10, 40544
    s_add_u32 s14, s60, 24576
    buffer_load_dwordx4 v6, s[44:47], s14 offen lds
    s_waitcnt lgkmcnt(0)
    v_mfma_f32_16x16x32_bf16 v[52:55], v[76:79], v[80:83], v[52:55]
    v_mfma_f32_16x16x32_bf16 v[56:59], v[76:79], v[84:87], v[56:59]
    v_mfma_f32_16x16x32_bf16 v[60:63], v[76:79], v[88:91], v[60:63]
    s_waitcnt vmcnt(10)
    s_barrier
    ds_read_b128 v[80:83], v99
    ds_read_b128 v[84:87], v99 offset:1024
    ds_read_b128 v[88:91], v99 offset:2048
    ds_read_b64_tr_b16 v[64:65], v95
    ds_read_b64_tr_b16 v[66:67], v95 offset:4224
    ds_read_b64_tr_b16 v[68:69], v95 offset:32
    ds_read_b64_tr_b16 v[70:71], v95 offset:4256
    ds_read_b64_tr_b16 v[72:73], v95 offset:64
    ds_read_b64_tr_b16 v[74:75], v95 offset:4288
    ds_read_b64_tr_b16 v[76:77], v95 offset:96
    ds_read_b64_tr_b16 v[78:79], v95 offset:4320
    s_add_u32 s60, s5, 13
    s_and_b32 s60, s60, 15
    s_lshl_b32 s61, s60, 6
    s_mul_i32 s60, s60, 262144
    s_add_u32 s60, s60, s11
    s_add_u32 m0, s63, 109056
    s_add_u32 s14, s15, s61
    s_mov_b64 exec, 0xffffff
    buffer_load_dwordx4 v100, s[40:43], s14 offen lds
    s_mov_b64 exec, -1
    s_add_u32 m0, s10, 74752
    s_add_u32 s14, s60, 0
    buffer_load_dwordx4 v6, s[44:47], s14 offen lds
    s_waitcnt lgkmcnt(6)
    v_mfma_f32_16x16x32_bf16 v[16:19], v[64:67], v[80:83], v[16:19]
    v_mfma_f32_16x16x32_bf16 v[20:23], v[64:67], v[84:87], v[20:23]
    v_mfma_f32_16x16x32_bf16 v[24:27], v[64:67], v[88:91], v[24:27]
    s_add_u32 m0, s10, 75808
    s_add_u32 s14, s60, 8192
    buffer_load_dwordx4 v6, s[44:47], s14 offen lds
    s_waitcnt lgkmcnt(4)
    v_mfma_f32_16x16x32_bf16 v[28:31], v[68:71], v[80:83], v[28:31]
    v_mfma_f32_16x16x32_bf16 v[32:35], v[68:71], v[84:87], v[32:35]
    v_mfma_f32_16x16x32_bf16 v[36:39], v[68:71], v[88:91], v[36:39]
    s_add_u32 m0, s10, 76864
    s_add_u32 s14, s60, 16384
    buffer_load_dwordx4 v6, s[44:47], s14 offen lds
    s_waitcnt lgkmcnt(2)
    v_mfma_f32_16x16x32_bf16 v[40:43], v[72:75], v[80:83], v[40:43]
    v_mfma_f32_16x16x32_bf16 v[44:47], v[72:75], v[84:87], v[44:47]
    v_mfma_f32_16x16x32_bf16 v[48:51], v[72:75], v[88:91], v[48:51]
    s_add_u32 m0, s10, 77920
    s_add_u32 s14, s60, 24576
    buffer_load_dwordx4 v6, s[44:47], s14 offen lds
    s_waitcnt lgkmcnt(0)
    v_mfma_f32_16x16x32_bf16 v[52:55], v[76:79], v[80:83], v[52:55]
    v_mfma_f32_16x16x32_bf16 v[56:59], v[76:79], v[84:87], v[56:59]
    v_mfma_f32_16x16x32_bf16 v[60:63], v[76:79], v[88:91], v[60:63]
    s_waitcnt vmcnt(10)
    s_barrier
    ds_read_b128 v[80:83], v96
    ds_read_b128 v[84:87], v96 offset:1024
    ds_read_b128 v[88:91], v96 offset:2048
    ds_read_b64_tr_b16 v[64:65], v92
    ds_read_b64_tr_b16 v[66:67], v92 offset:4224
    ds_read_b64_tr_b16 v[68:69], v92 offset:32
    ds_read_b64_tr_b16 v[70:71], v92 offset:4256
    ds_read_b64_tr_b16 v[72:73], v92 offset:64
    ds_read_b64_tr_b16 v[74:75], v92 offset:4288
    ds_read_b64_tr_b16 v[76:77], v92 offset:96
    ds_read_b64_tr_b16 v[78:79], v92 offset:4320
    s_add_u32 s60, s5, 14
    s_and_b32 s60, s60, 15
    s_lshl_b32 s61, s60, 6
    s_mul_i32 s60, s60, 262144
    s_add_u32 s60, s60, s11
    s_add_u32 m0, s63, 146432
    s_add_u32 s14, s15, s61
    s_mov_b64 exec, 0xffffff
    buffer_load_dwordx4 v100, s[40:43], s14 offen lds
    s_mov_b64 exec, -1
    s_add_u32 m0, s10, 112128
    s_add_u32 s14, s60, 0
    buffer_load_dwordx4 v6, s[44:47], s14 offen lds
    s_waitcnt lgkmcnt(6)
    v_mfma_f32_16x16x32_bf16 v[16:19], v[64:67], v[80:83], v[16:19]
    v_mfma_f32_16x16x32_bf16 v[20:23], v[64:67], v[84:87], v[20:23]
    v_mfma_f32_16x16x32_bf16 v[24:27], v[64:67], v[88:91], v[24:27]
    s_add_u32 m0, s10, 113184
    s_add_u32 s14, s60, 8192
    buffer_load_dwordx4 v6, s[44:47], s14 offen lds
    s_waitcnt lgkmcnt(4)
    v_mfma_f32_16x16x32_bf16 v[28:31], v[68:71], v[80:83], v[28:31]
    v_mfma_f32_16x16x32_bf16 v[32:35], v[68:71], v[84:87], v[32:35]
    v_mfma_f32_16x16x32_bf16 v[36:39], v[68:71], v[88:91], v[36:39]
    s_add_u32 m0, s10, 114240
    s_add_u32 s14, s60, 16384
    buffer_load_dwordx4 v6, s[44:47], s14 offen lds
    s_waitcnt lgkmcnt(2)
    v_mfma_f32_16x16x32_bf16 v[40:43], v[72:75], v[80:83], v[40:43]
    v_mfma_f32_16x16x32_bf16 v[44:47], v[72:75], v[84:87], v[44:47]
    v_mfma_f32_16x16x32_bf16 v[48:51], v[72:75], v[88:91], v[48:51]
    s_add_u32 m0, s10, 115296
    s_add_u32 s14, s60, 24576
    buffer_load_dwordx4 v6, s[44:47], s14 offen lds
    s_waitcnt lgkmcnt(0)
    v_mfma_f32_16x16x32_bf16 v[52:55], v[76:79], v[80:83], v[52:55]
    v_mfma_f32_16x16x32_bf16 v[56:59], v[76:79], v[84:87], v[56:59]
    v_mfma_f32_16x16x32_bf16 v[60:63], v[76:79], v[88:91], v[60:63]
    s_waitcnt vmcnt(10)
    s_barrier
    ds_read_b128 v[80:83], v97
    ds_read_b128 v[84:87], v97 offset:1024
    ds_read_b128 v[88:91], v97 offset:2048
    ds_read_b64_tr_b16 v[64:65], v93
    ds_read_b64_tr_b16 v[66:67], v93 offset:4224
    ds_read_b64_tr_b16 v[68:69], v93 offset:32
    ds_read_b64_tr_b16 v[70:71], v93 offset:4256
    ds_read_b64_tr_b16 v[72:73], v93 offset:64
    ds_read_b64_tr_b16 v[74:75], v93 offset:4288
    ds_read_b64_tr_b16 v[76:77], v93 offset:96
    ds_read_b64_tr_b16 v[78:79], v93 offset:4320
    s_add_u32 s60, s5, 15
    s_and_b32 s60, s60, 15
    s_lshl_b32 s61, s60, 6
    s_mul_i32 s60, s60, 262144
    s_add_u32 s60, s60, s11
    s_add_u32 m0, s63, 34304
    s_add_u32 s14, s15, s61
    s_mov_b64 exec, 0xffffff
    buffer_load_dwordx4 v100, s[40:43], s14 offen lds
    s_mov_b64 exec, -1
    s_add_u32 m0, s10, 0
    s_add_u32 s14, s60, 0
    buffer_load_dwordx4 v6, s[44:47], s14 offen lds
    s_waitcnt lgkmcnt(6)
    v_mfma_f32_16x16x32_bf16 v[16:19], v[64:67], v[80:83], v[16:19]
    v_mfma_f32_16x16x32_bf16 v[20:23], v[64:67], v[84:87], v[20:23]
    v_mfma_f32_16x16x32_bf16 v[24:27], v[64:67], v[88:91], v[24:27]
    s_add_u32 m0, s10, 1056
    s_add_u32 s14, s60, 8192
    buffer_load_dwordx4 v6, s[44:47], s14 offen lds
    s_waitcnt lgkmcnt(4)
    v_mfma_f32_16x16x32_bf16 v[28:31], v[68:71], v[80:83], v[28:31]
    v_mfma_f32_16x16x32_bf16 v[32:35], v[68:71], v[84:87], v[32:35]
    v_mfma_f32_16x16x32_bf16 v[36:39], v[68:71], v[88:91], v[36:39]
    s_add_u32 m0, s10, 2112
    s_add_u32 s14, s60, 16384
    buffer_load_dwordx4 v6, s[44:47], s14 offen lds
    s_waitcnt lgkmcnt(2)
    v_mfma_f32_16x16x32_bf16 v[40:43], v[72:75], v[80:83], v[40:43]
    v_mfma_f32_16x16x32_bf16 v[44:47], v[72:75], v[84:87], v[44:47]
    v_mfma_f32_16x16x32_bf16 v[48:51], v[72:75], v[88:91], v[48:51]
    s_add_u32 m0, s10, 3168
    s_add_u32 s14, s60, 24576
    buffer_load_dwordx4 v6, s[44:47], s14 offen lds
    s_waitcnt lgkmcnt(0)
    v_mfma_f32_16x16x32_bf16 v[52:55], v[76:79], v[80:83], v[52:55]
    v_mfma_f32_16x16x32_bf16 v[56:59], v[76:79], v[84:87], v[56:59]
    v_mfma_f32_16x16x32_bf16 v[60:63], v[76:79], v[88:91], v[60:63]
    s_waitcnt vmcnt(10)
    s_barrier
    ds_read_b128 v[80:83], v98
    ds_read_b128 v[84:87], v98 offset:1024
    ds_read_b128 v[88:91], v98 offset:2048
    ds_read_b64_tr_b16 v[64:65], v94
    ds_read_b64_tr_b16 v[66:67], v94 offset:4224
    ds_read_b64_tr_b16 v[68:69], v94 offset:32
    ds_read_b64_tr_b16 v[70:71], v94 offset:4256
    ds_read_b64_tr_b16 v[72:73], v94 offset:64
    ds_read_b64_tr_b16 v[74:75], v94 offset:4288
    ds_read_b64_tr_b16 v[76:77], v94 offset:96
    ds_read_b64_tr_b16 v[78:79], v94 offset:4320
    s_cmp_ge_u32 s3, 4
    s_cbranch_scc0 L_2
    s_add_u32 s14, s37, 0
    buffer_load_dwordx4 v[128:131], v6, s[52:55], s14 offen nt
    s_add_u32 s14, s37, 1024
    buffer_load_dwordx4 v[132:135], v6, s[52:55], s14 offen nt
L_2:
    s_waitcnt lgkmcnt(6)
    v_mfma_f32_16x16x32_bf16 v[16:19], v[64:67], v[80:83], v[16:19]
    v_mfma_f32_16x16x32_bf16 v[20:23], v[64:67], v[84:87], v[20:23]
    v_mfma_f32_16x16x32_bf16 v[24:27], v[64:67], v[88:91], v[24:27]
    s_cmp_ge_u32 s3, 4
    s_cbranch_scc0 L_3
    s_add_u32 s14, s37, 2048
    buffer_load_dwordx4 v[136:139], v6, s[52:55], s14 offen nt
    s_add_u32 s14, s37, 3072
    buffer_load_dwordx4 v[140:143], v6, s[52:55], s14 offen nt
L_3:
    s_waitcnt lgkmcnt(4)
    v_mfma_f32_16x16x32_bf16 v[28:31], v[68:71], v[80:83], v[28:31]
    v_mfma_f32_16x16x32_bf16 v[32:35], v[68:71], v[84:87], v[32:35]
    v_mfma_f32_16x16x32_bf16 v[36:39], v[68:71], v[88:91], v[36:39]
    s_cmp_ge_u32 s3, 4
    s_cbranch_scc0 L_4
    s_add_u32 s14, s37, 4096
    buffer_load_dwordx4 v[144:147], v6, s[52:55], s14 offen nt
    s_add_u32 s14, s37, 5120
    buffer_load_dwordx4 v[148:151], v6, s[52:55], s14 offen nt
L_4:
    s_waitcnt lgkmcnt(2)
    v_mfma_f32_16x16x32_bf16 v[40:43], v[72:75], v[80:83], v[40:43]
    v_mfma_f32_16x16x32_bf16 v[44:47], v[72:75], v[84:87], v[44:47]
    v_mfma_f32_16x16x32_bf16 v[48:51], v[72:75], v[88:91], v[48:51]
    s_cmp_ge_u32 s3, 4
    s_cbranch_scc0 L_5
    s_add_u32 s14, s37, 6144
    buffer_load_dwordx4 v[152:155], v6, s[52:55], s14 offen nt
    s_add_u32 s14, s37, 7168
    buffer_load_dwordx4 v[156:159], v6, s[52:55], s14 offen nt
L_5:
    s_waitcnt lgkmcnt(0)
    v_mfma_f32_16x16x32_bf16 v[52:55], v[76:79], v[80:83], v[52:55]
    v_mfma_f32_16x16x32_bf16 v[56:59], v[76:79], v[84:87], v[56:59]
    v_mfma_f32_16x16x32_bf16 v[60:63], v[76:79], v[88:91], v[60:63]
    s_cmp_ge_u32 s3, 4
    s_cbranch_scc1 L_6
    s_waitcnt vmcnt(5)
L_6:
    s_cmp_ge_u32 s3, 4
    s_cbranch_scc0 L_7
    s_waitcnt vmcnt(13)
L_7:
    s_barrier
    ds_read_b128 v[80:83], v99
    ds_read_b128 v[84:87], v99 offset:1024
    ds_read_b128 v[88:91], v99 offset:2048
    ds_read_b64_tr_b16 v[64:65], v95
    ds_read_b64_tr_b16 v[66:67], v95 offset:4224
    ds_read_b64_tr_b16 v[68:69], v95 offset:32
    ds_read_b64_tr_b16 v[70:71], v95 offset:4256
    ds_read_b64_tr_b16 v[72:73], v95 offset:64
    ds_read_b64_tr_b16 v[74:75], v95 offset:4288
    ds_read_b64_tr_b16 v[76:77], v95 offset:96
    ds_read_b64_tr_b16 v[78:79], v95 offset:4320
    s_cmp_ge_u32 s3, 4
    s_cbranch_scc0 L_8
    s_add_u32 s14, s37, 8192
    buffer_load_dwordx4 v[160:163], v6, s[52:55], s14 offen nt
    s_add_u32 s14, s37, 9216
    buffer_load_dwordx4 v[164:167], v6, s[52:55], s14 offen nt
L_8:
    s_waitcnt lgkmcnt(6)
    v_mfma_f32_16x16x32_bf16 v[16:19], v[64:67], v[80:83], v[16:19]
    v_mfma_f32_16x16x32_bf16 v[20:23], v[64:67], v[84:87], v[20:23]
    v_mfma_f32_16x16x32_bf16 v[24:27], v[64:67], v[88:91], v[24:27]
    s_cmp_ge_u32 s3, 4
    s_cbranch_scc0 L_9
    s_add_u32 s14, s37, 10240
    buffer_load_dwordx4 v[168:171], v6, s[52:55], s14 offen nt
    s_add_u32 s14, s37, 11264
    buffer_load_dwordx4 v[172:175], v6, s[52:55], s14 offen nt
L_9:
    s_waitcnt lgkmcnt(4)
    v_mfma_f32_16x16x32_bf16 v[28:31], v[68:71], v[80:83], v[28:31]
    v_mfma_f32_16x16x32_bf16 v[32:35], v[68:71], v[84:87], v[32:35]
    v_mfma_f32_16x16x32_bf16 v[36:39], v[68:71], v[88:91], v[36:39]
    s_cmp_ge_u32 s3, 4
    s_cbranch_scc0 L_10
    s_add_u32 s14, s37, 12288
    buffer_load_dwordx4 v[176:179], v6, s[52:55], s14 offen nt
    s_add_u32 s14, s37, 13312
    buffer_load_dwordx4 v[180:183], v6, s[52:55], s14 offen nt
L_10:
    s_waitcnt lgkmcnt(2)
    v_mfma_f32_16x16x32_bf16 v[40:43], v[72:75], v[80:83], v[40:43]
    v_mfma_f32_16x16x32_bf16 v[44:47], v[72:75], v[84:87], v[44:47]
    v_mfma_f32_16x16x32_bf16 v[48:51], v[72:75], v[88:91], v[48:51]
    s_cmp_ge_u32 s3, 4
    s_cbranch_scc0 L_11
    s_add_u32 s14, s37, 14336
    buffer_load_dwordx4 v[184:187], v6, s[52:55], s14 offen nt
    s_add_u32 s14, s37, 15360
    buffer_load_dwordx4 v[188:191], v6, s[52:55], s14 offen nt
L_11:
    s_waitcnt lgkmcnt(0)
    v_mfma_f32_16x16x32_bf16 v[52:55], v[76:79], v[80:83], v[52:55]
    v_mfma_f32_16x16x32_bf16 v[56:59], v[76:79], v[84:87], v[56:59]
    v_mfma_f32_16x16x32_bf16 v[60:63], v[76:79], v[88:91], v[60:63]
    s_cmp_ge_u32 s3, 4
    s_cbranch_scc1 L_12
    s_waitcnt vmcnt(0)
L_12:
    s_cmp_ge_u32 s3, 4
    s_cbranch_scc0 L_13
    s_waitcnt vmcnt(16)
L_13:
    s_barrier
    ds_read_b128 v[80:83], v96
    ds_read_b128 v[84:87], v96 offset:1024
    ds_read_b128 v[88:91], v96 offset:2048
    ds_read_b64_tr_b16 v[64:65], v92
    ds_read_b64_tr_b16 v[66:67], v92 offset:4224
    ds_read_b64_tr_b16 v[68:69], v92 offset:32
    ds_read_b64_tr_b16 v[70:71], v92 offset:4256
    ds_read_b64_tr_b16 v[72:73], v92 offset:64
    ds_read_b64_tr_b16 v[74:75], v92 offset:4288
    ds_read_b64_tr_b16 v[76:77], v92 offset:96
    ds_read_b64_tr_b16 v[78:79], v92 offset:4320
    s_waitcnt lgkmcnt(6)
    v_mfma_f32_16x16x32_bf16 v[16:19], v[64:67], v[80:83], v[16:19]
    v_mfma_f32_16x16x32_bf16 v[20:23], v[64:67], v[84:87], v[20:23]
    v_mfma_f32_16x16x32_bf16 v[24:27], v[64:67], v[88:91], v[24:27]
    s_waitcnt lgkmcnt(4)
    v_mfma_f32_16x16x32_bf16 v[28:31], v[68:71], v[80:83], v[28:31]
    v_mfma_f32_16x16x32_bf16 v[32:35], v[68:71], v[84:87], v[32:35]
    v_mfma_f32_16x16x32_bf16 v[36:39], v[68:71], v[88:91], v[36:39]
    s_waitcnt lgkmcnt(2)
    v_mfma_f32_16x16x32_bf16 v[40:43], v[72:75], v[80:83], v[40:43]
    v_mfma_f32_16x16x32_bf16 v[44:47], v[72:75], v[84:87], v[44:47]
    v_mfma_f32_16x16x32_bf16 v[48:51], v[72:75], v[88:91], v[48:51]
    s_waitcnt lgkmcnt(0)
    v_mfma_f32_16x16x32_bf16 v[52:55], v[76:79], v[80:83], v[52:55]
    v_mfma_f32_16x16x32_bf16 v[56:59], v[76:79], v[84:87], v[56:59]
    v_mfma_f32_16x16x32_bf16 v[60:63], v[76:79], v[88:91], v[60:63]
    v_mul_u32_u24 v12, 1056, v2
    v_lshlrev_b32 v13, 3, v3
    v_add_u32 v12, v12, v13
    s_lshl_b32 s13, s3, 7
    s_add_u32 s13, s13, 113152
    v_add_u32 v12, s13, v12
    v_cvt_pk_bf16_f32 v16, v16, v17
    v_cvt_pk_bf16_f32 v17, v18, v19
    ds_write_b64 v12, v[16:17]
    v_cvt_pk_bf16_f32 v20, v20, v21
    v_cvt_pk_bf16_f32 v21, v22, v23
    ds_write_b64 v12, v[20:21] offset:16896
    v_cvt_pk_bf16_f32 v24, v24, v25
    v_cvt_pk_bf16_f32 v25, v26, v27
    ds_write_b64 v12, v[24:25] offset:33792
    v_cvt_pk_bf16_f32 v28, v28, v29
    v_cvt_pk_bf16_f32 v29, v30, v31
    ds_write_b64 v12, v[28:29] offset:32
    v_cvt_pk_bf16_f32 v32, v32, v33
    v_cvt_pk_bf16_f32 v33, v34, v35
    ds_write_b64 v12, v[32:33] offset:16928
    v_cvt_pk_bf16_f32 v36, v36, v37
    v_cvt_pk_bf16_f32 v37, v38, v39
    ds_write_b64 v12, v[36:37] offset:33824
    v_cvt_pk_bf16_f32 v40, v40, v41
    v_cvt_pk_bf16_f32 v41, v42, v43
    ds_write_b64 v12, v[40:41] offset:64
    v_cvt_pk_bf16_f32 v44, v44, v45
    v_cvt_pk_bf16_f32 v45, v46, v47
    ds_write_b64 v12, v[44:45] offset:16960
    v_cvt_pk_bf16_f32 v48, v48, v49
    v_cvt_pk_bf16_f32 v49, v50, v51
    ds_write_b64 v12, v[48:49] offset:33856
    v_cvt_pk_bf16_f32 v52, v52, v53
    v_cvt_pk_bf16_f32 v53, v54, v55
    ds_write_b64 v12, v[52:53] offset:96
    v_cvt_pk_bf16_f32 v56, v56, v57
    v_cvt_pk_bf16_f32 v57, v58, v59
    ds_write_b64 v12, v[56:57] offset:16992
    v_cvt_pk_bf16_f32 v60, v60, v61
    v_cvt_pk_bf16_f32 v61, v62, v63
    ds_write_b64 v12, v[60:61] offset:33888
    v_add_u32 v13, 0, v3
    v_and_b32 v14, 7, v13
    v_lshlrev_b32 v14, 1, v14
    s_cmp_eq_u32 s8, 0
    s_cselect_b64 vcc, -1, 0
    v_cndmask_b32 v13, v14, v13, vcc
    v_xor_b32 v13, v13, v2
    v_lshlrev_b32 v13, 4, v13
    v_lshlrev_b32 v14, 8, v3
    v_add_u32 v92, v13, v14
    v_add_u32 v13, 4, v3
    v_and_b32 v14, 7, v13
    v_lshlrev_b32 v14, 1, v14
    s_cmp_eq_u32 s8, 0
    s_cselect_b64 vcc, -1, 0
    v_cndmask_b32 v13, v14, v13, vcc
    v_xor_b32 v13, v13, v2
    v_lshlrev_b32 v13, 4, v13
    v_lshlrev_b32 v14, 8, v3
    v_add_u32 v93, v13, v14
    v_add_u32 v13, 8, v3
    v_and_b32 v14, 7, v13
    v_lshlrev_b32 v14, 1, v14
    s_cmp_eq_u32 s8, 0
    s_cselect_b64 vcc, -1, 0
    v_cndmask_b32 v13, v14, v13, vcc
    v_xor_b32 v13, v13, v2
    v_lshlrev_b32 v13, 4, v13
    v_lshlrev_b32 v14, 8, v3
    v_add_u32 v94, v13, v14
    v_add_u32 v13, 12, v3
    v_and_b32 v14, 7, v13
    v_lshlrev_b32 v14, 1, v14
    s_cmp_eq_u32 s8, 0
    s_cselect_b64 vcc, -1, 0
    v_cndmask_b32 v13, v14, v13, vcc
    v_xor_b32 v13, v13, v2
    v_lshlrev_b32 v13, 4, v13
    v_lshlrev_b32 v14, 8, v3
    v_add_u32 v95, v13, v14
    s_lshr_b32 s13, s3, 2
    s_lshl_b32 s13, s13, 16
    s_add_u32 s15, s36, s13
    s_and_b32 s13, s3, 1
    s_lshl_b32 s13, s13, 13
    s_add_u32 s15, s15, s13
    s_lshl_b32 s9, s3, 13
    s_lshr_b32 s13, s3, 2
    s_lshl_b32 s13, s13, 15
    v_xor_b32 v13, v3, v2
    v_lshlrev_b32 v13, 4, v13
    v_lshlrev_b32 v14, 8, v2
    v_add_u32 v13, v13, v14
    v_add_u32 v96, s13, v13
    v_xor_b32 v97, 64, v96
    v_xor_b32 v98, 128, v96
    v_xor_b32 v99, 192, v96
    v_lshlrev_b32 v13, 2, v3
    v_add_u32 v13, v13, v4
    v_and_b32 v14, 7, v13
    v_lshlrev_b32 v14, 5, v14
    v_lshlrev_b32 v13, 8, v13
    v_add_u32 v13, v13, v14
    v_lshlrev_b32 v14, 3, v5
    v_add_u32 v13, v13, v14
    s_add_u32 s13, s13, 16384
    v_add_u32 v100, s13, v13
    v_xor_b32 v101, 32, v100
    v_xor_b32 v102, 64, v100
    v_xor_b32 v103, 96, v100
    v_xor_b32 v104, 128, v100
    v_xor_b32 v105, 160, v100
    v_xor_b32 v106, 192, v100
    v_xor_b32 v107, 224, v100
    s_and_b32 s13, s3, 1
    s_lshl_b32 s13, s13, 1
    s_add_u32 s13, s13, s8
    s_lshl_b32 s13, s13, 14
    v_add_u32 v64, s13, v92
    v_add_u32 v65, s13, v93
    v_add_u32 v66, s13, v94
    v_add_u32 v67, s13, v95
    s_waitcnt lgkmcnt(0)
    s_barrier
    s_cmp_ge_u32 s3, 4
    s_cbranch_scc0 L_14
    s_waitcnt vmcnt(0)
    ds_write_b128 v64, v[128:131]
    ds_write_b128 v65, v[132:135] offset:1024
    ds_write_b128 v66, v[136:139] offset:2048
    ds_write_b128 v67, v[140:143] offset:3072
    ds_write_b128 v64, v[144:147] offset:4096
    ds_write_b128 v65, v[148:151] offset:5120
    ds_write_b128 v66, v[152:155] offset:6144
    ds_write_b128 v67, v[156:159] offset:7168
    ds_write_b128 v64, v[160:163] offset:8192
    ds_write_b128 v65, v[164:167] offset:9216
    ds_write_b128 v66, v[168:171] offset:10240
    ds_write_b128 v67, v[172:175] offset:11264
    ds_write_b128 v64, v[176:179] offset:12288
    ds_write_b128 v65, v[180:183] offset:13312
    ds_write_b128 v66, v[184:187] offset:14336
    ds_write_b128 v67, v[188:191] offset:15360
L_14:
    s_and_b32 s13, s3, 3
    s_lshl_b32 s13, s13, 8
    s_add_u32 s13, s13, 113152
    v_add_u32 v13, s13, v11
    ds_read_b128 v[16:19], v13
    ds_read_b128 v[20:23], v13 offset:64
    ds_read_b128 v[24:27], v13 offset:128
    ds_read_b128 v[28:31], v13 offset:192
    ds_read_b128 v[32:35], v13 offset:16896
    ds_read_b128 v[36:39], v13 offset:16960
    ds_read_b128 v[40:43], v13 offset:17024
    ds_read_b128 v[44:47], v13 offset:17088
    ds_read_b128 v[48:51], v13 offset:33792
    ds_read_b128 v[52:55], v13 offset:33856
    ds_read_b128 v[56:59], v13 offset:33920
    ds_read_b128 v[60:63], v13 offset:33984
    s_waitcnt lgkmcnt(0)
    s_barrier
    s_add_u32 m0, s9, 65536
    s_add_u32 s14, s15, 16384
    buffer_load_dwordx4 v92, s[52:55], s14 offen nt lds
    s_add_u32 m0, s9, 66560
    s_add_u32 s14, s15, 17408
    buffer_load_dwordx4 v93, s[52:55], s14 offen nt lds
    s_add_u32 m0, s9, 67584
    s_add_u32 s14, s15, 18432
    buffer_load_dwordx4 v94, s[52:55], s14 offen nt lds
    s_add_u32 m0, s9, 68608
    s_add_u32 s14, s15, 19456
    buffer_load_dwordx4 v95, s[52:55], s14 offen nt lds
    s_add_u32 m0, s9, 69632
    s_add_u32 s14, s15, 20480
    buffer_load_dwordx4 v92, s[52:55], s14 offen nt lds
    s_add_u32 m0, s9, 70656
    s_add_u32 s14, s15, 21504
    buffer_load_dwordx4 v93, s[52:55], s14 offen nt lds
    s_add_u32 m0, s9, 71680
    s_add_u32 s14, s15, 22528
    buffer_load_dwordx4 v94, s[52:55], s14 offen nt lds
    s_add_u32 m0, s9, 72704
    s_add_u32 s14, s15, 23552
    buffer_load_dwordx4 v95, s[52:55], s14 offen nt lds
    s_mov_b32 s13, 1040356334
    s_mov_b32 s62, 1115353651
    v_mov_b32 v116, 1065369472
    v_mov_b32 v117, 1065369472
    v_mov_b32 v118, 1065369472
    v_mov_b32 v119, 1065369472
    s_cmp_ge_u32 s3, 4
    s_cbranch_scc1 L_15
    s_setprio 1
L_15:
    ds_read_b128 v[64:67], v96
    ds_read_b128 v[68:71], v97
    ds_read_b128 v[72:75], v98
    ds_read_b128 v[76:79], v99
    s_waitcnt lgkmcnt(3)
    v_mfma_f32_16x16x32_bf16 v[224:227], v[64:67], v[16:19], 0
    v_mfma_f32_16x16x32_bf16 v[228:231], v[64:67], v[32:35], 0
    v_mfma_f32_16x16x32_bf16 v[232:235], v[64:67], v[48:51], 0
    ds_read_b128 v[64:67], v96 offset:4096
    s_waitcnt lgkmcnt(3)
    v_mfma_f32_16x16x32_bf16 v[224:227], v[68:71], v[20:23], v[224:227]
    v_mfma_f32_16x16x32_bf16 v[228:231], v[68:71], v[36:39], v[228:231]
    v_mfma_f32_16x16x32_bf16 v[232:235], v[68:71], v[52:55], v[232:235]
    ds_read_b128 v[68:71], v97 offset:4096
    s_waitcnt lgkmcnt(3)
    v_mfma_f32_16x16x32_bf16 v[224:227], v[72:75], v[24:27], v[224:227]
    v_mfma_f32_16x16x32_bf16 v[228:231], v[72:75], v[40:43], v[228:231]
    v_mfma_f32_16x16x32_bf16 v[232:235], v[72:75], v[56:59], v[232:235]
    ds_read_b128 v[72:75], v98 offset:4096
    s_waitcnt lgkmcnt(3)
    v_mfma_f32_16x16x32_bf16 v[224:227], v[76:79], v[28:31], v[224:227]
    v_mfma_f32_16x16x32_bf16 v[228:231], v[76:79], v[44:47], v[228:231]
    v_mfma_f32_16x16x32_bf16 v[232:235], v[76:79], v[60:63], v[232:235]
    ds_read_b128 v[76:79], v99 offset:4096
    s_waitcnt lgkmcnt(3)
    v_mfma_f32_16x16x32_bf16 v[236:239], v[64:67], v[16:19], 0
    v_mfma_f32_16x16x32_bf16 v[240:243], v[64:67], v[32:35], 0
    v_mfma_f32_16x16x32_bf16 v[244:247], v[64:67], v[48:51], 0
    ds_read_b128 v[64:67], v96 offset:8192
    s_waitcnt lgkmcnt(3)
    v_mfma_f32_16x16x32_bf16 v[236:239], v[68:71], v[20:23], v[236:239]
    v_mfma_f32_16x16x32_bf16 v[240:243], v[68:71], v[36:39], v[240:243]
    v_mfma_f32_16x16x32_bf16 v[244:247], v[68:71], v[52:55], v[244:247]
    ds_read_b128 v[68:71], v97 offset:8192
    s_waitcnt lgkmcnt(3)
    v_mfma_f32_16x16x32_bf16 v[236:239], v[72:75], v[24:27], v[236:239]
    v_mfma_f32_16x16x32_bf16 v[240:243], v[72:75], v[40:43], v[240:243]
    v_mfma_f32_16x16x32_bf16 v[244:247], v[72:75], v[56:59], v[244:247]
    ds_read_b128 v[72:75], v98 offset:8192
    s_waitcnt lgkmcnt(3)
    v_mfma_f32_16x16x32_bf16 v[236:239], v[76:79], v[28:31], v[236:239]
    v_mfma_f32_16x16x32_bf16 v[240:243], v[76:79], v[44:47], v[240:243]
    v_mfma_f32_16x16x32_bf16 v[244:247], v[76:79], v[60:63], v[244:247]
    ds_read_b128 v[76:79], v99 offset:8192
    s_waitcnt lgkmcnt(3)
    v_mfma_f32_16x16x32_bf16 v[248:251], v[64:67], v[16:19], 0
    v_mfma_f32_16x16x32_bf16 v[252:255], v[64:67], v[32:35], 0
    v_mfma_f32_16x16x32_bf16 v[80:83], v[64:67], v[48:51], 0
    ds_read_b128 v[64:67], v96 offset:12288
    s_waitcnt lgkmcnt(3)
    v_mfma_f32_16x16x32_bf16 v[248:251], v[68:71], v[20:23], v[248:251]
    v_mfma_f32_16x16x32_bf16 v[252:255], v[68:71], v[36:39], v[252:255]
    v_mfma_f32_16x16x32_bf16 v[80:83], v[68:71], v[52:55], v[80:83]
    ds_read_b128 v[68:71], v97 offset:12288
    s_waitcnt lgkmcnt(3)
    v_mfma_f32_16x16x32_bf16 v[248:251], v[72:75], v[24:27], v[248:251]
    v_mfma_f32_16x16x32_bf16 v[252:255], v[72:75], v[40:43], v[252:255]
    v_mfma_f32_16x16x32_bf16 v[80:83], v[72:75], v[56:59], v[80:83]
    ds_read_b128 v[72:75], v98 offset:12288
    s_waitcnt lgkmcnt(3)
    v_mfma_f32_16x16x32_bf16 v[248:251], v[76:79], v[28:31], v[248:251]
    v_mfma_f32_16x16x32_bf16 v[252:255], v[76:79], v[44:47], v[252:255]
    v_mfma_f32_16x16x32_bf16 v[80:83], v[76:79], v[60:63], v[80:83]
    ds_read_b128 v[76:79], v99 offset:12288
    s_waitcnt lgkmcnt(3)
    v_mfma_f32_16x16x32_bf16 v[84:87], v[64:67], v[16:19], 0
    v_mfma_f32_16x16x32_bf16 v[88:91], v[64:67], v[32:35], 0
    v_mfma_f32_16x16x32_bf16 v[12:15], v[64:67], v[48:51], 0
    s_waitcnt lgkmcnt(2)
    v_mfma_f32_16x16x32_bf16 v[84:87], v[68:71], v[20:23], v[84:87]
    v_mfma_f32_16x16x32_bf16 v[88:91], v[68:71], v[36:39], v[88:91]
    v_mfma_f32_16x16x32_bf16 v[12:15], v[68:71], v[52:55], v[12:15]
    s_waitcnt lgkmcnt(1)
    v_mfma_f32_16x16x32_bf16 v[84:87], v[72:75], v[24:27], v[84:87]
    v_mfma_f32_16x16x32_bf16 v[88:91], v[72:75], v[40:43], v[88:91]
    v_mfma_f32_16x16x32_bf16 v[12:15], v[72:75], v[56:59], v[12:15]
    s_waitcnt lgkmcnt(0)
    v_mfma_f32_16x16x32_bf16 v[84:87], v[76:79], v[28:31], v[84:87]
    v_mfma_f32_16x16x32_bf16 v[88:91], v[76:79], v[44:47], v[88:91]
    v_mfma_f32_16x16x32_bf16 v[12:15], v[76:79], v[60:63], v[12:15]
    ds_read_b64_tr_b16 v[64:65], v100
    ds_read_b64_tr_b16 v[66:67], v100 offset:4096
    ds_read_b64_tr_b16 v[68:69], v101
    ds_read_b64_tr_b16 v[70:71], v101 offset:4096
    ds_read_b64_tr_b16 v[72:73], v102
    ds_read_b64_tr_b16 v[74:75], v102 offset:4096
    v_max3_f32 v124, v224, v225, v226
    v_max3_f32 v124, v124, v227, v236
    v_max3_f32 v124, v124, v237, v238
    v_max3_f32 v124, v124, v239, v248
    v_max3_f32 v124, v124, v249, v250
    v_max3_f32 v124, v124, v251, v84
    v_max3_f32 v124, v124, v85, v86
    v_max_f32 v124, v124, v87
    v_max3_f32 v125, v228, v229, v230
    v_max3_f32 v125, v125, v231, v240
    v_max3_f32 v125, v125, v241, v242
    v_max3_f32 v125, v125, v243, v252
    v_max3_f32 v125, v125, v253, v254
    v_max3_f32 v125, v125, v255, v88
    v_max3_f32 v125, v125, v89, v90
    v_max_f32 v125, v125, v91
    v_max3_f32 v126, v232, v233, v234
    v_max3_f32 v126, v126, v235, v244
    v_max3_f32 v126, v126, v245, v246
    v_max3_f32 v126, v126, v247, v80
    v_max3_f32 v126, v126, v81, v82
    v_max3_f32 v126, v126, v83, v12
    v_max3_f32 v126, v126, v13, v14
    v_max_f32 v126, v126, v15
    v_mov_b32 v127, v124
    v_mov_b32 v114, v125
    v_mov_b32 v115, v126
    v_permlane32_swap_b32 v124, v127
    v_permlane32_swap_b32 v125, v114
    v_permlane32_swap_b32 v126, v115
    v_max_f32 v124, v124, v127
    v_max_f32 v125, v125, v114
    v_max_f32 v126, v126, v115
    v_mov_b32 v127, v124
    v_mov_b32 v114, v125
    v_mov_b32 v115, v126
    v_permlane16_swap_b32 v124, v127
    v_permlane16_swap_b32 v125, v114
    v_permlane16_swap_b32 v126, v115
    v_max_f32 v124, v124, v127
    v_max_f32 v125, v125, v114
    v_max_f32 v126, v126, v115
    v_mov_b32 v108, v124
    v_mov_b32 v109, v125
    v_mov_b32 v110, v126
    v_mul_f32 v124, s13, v108
    v_mul_f32 v125, s13, v109
    v_mul_f32 v126, s13, v110
    v_fma_f32 v224, v224, s13, -v124
    v_fma_f32 v225, v225, s13, -v124
    v_fma_f32 v226, v226, s13, -v124
    v_fma_f32 v227, v227, s13, -v124
    v_fma_f32 v236, v236, s13, -v124
    v_fma_f32 v237, v237, s13, -v124
    v_fma_f32 v238, v238, s13, -v124
    v_fma_f32 v239, v239, s13, -v124
    v_fma_f32 v248, v248, s13, -v124
    v_fma_f32 v249, v249, s13, -v124
    v_fma_f32 v250, v250, s13, -v124
    v_fma_f32 v251, v251, s13, -v124
    v_fma_f32 v84, v84, s13, -v124
    v_fma_f32 v85, v85, s13, -v124
    v_fma_f32 v86, v86, s13, -v124
    v_fma_f32 v87, v87, s13, -v124
    v_exp_f32 v224, v224
    v_exp_f32 v225, v225
    v_exp_f32 v226, v226
    v_exp_f32 v227, v227
    v_exp_f32 v236, v236
    v_exp_f32 v237, v237
    v_exp_f32 v238, v238
    v_exp_f32 v239, v239
    v_exp_f32 v248, v248
    v_exp_f32 v249, v249
    v_exp_f32 v250, v250
    v_exp_f32 v251, v251
    v_exp_f32 v84, v84
    v_exp_f32 v85, v85
    v_exp_f32 v86, v86
    v_exp_f32 v87, v87
    v_cvt_pk_bf16_f32 v224, v224, v225
    v_cvt_pk_bf16_f32 v225, v226, v227
    v_cvt_pk_bf16_f32 v226, v236, v237
    v_cvt_pk_bf16_f32 v227, v238, v239
    v_cvt_pk_bf16_f32 v248, v248, v249
    v_cvt_pk_bf16_f32 v249, v250, v251
    v_cvt_pk_bf16_f32 v250, v84, v85
    v_cvt_pk_bf16_f32 v251, v86, v87
    v_fma_f32 v228, v228, s13, -v125
    v_fma_f32 v229, v229, s13, -v125
    v_fma_f32 v230, v230, s13, -v125
    v_fma_f32 v231, v231, s13, -v125
    v_fma_f32 v240, v240, s13, -v125
    v_fma_f32 v241, v241, s13, -v125
    v_fma_f32 v242, v242, s13, -v125
    v_fma_f32 v243, v243, s13, -v125
    v_fma_f32 v252, v252, s13, -v125
    v_fma_f32 v253, v253, s13, -v125
    v_fma_f32 v254, v254, s13, -v125
    v_fma_f32 v255, v255, s13, -v125
    v_fma_f32 v88, v88, s13, -v125
    v_fma_f32 v89, v89, s13, -v125
    v_fma_f32 v90, v90, s13, -v125
    v_fma_f32 v91, v91, s13, -v125
    v_exp_f32 v228, v228
    v_exp_f32 v229, v229
    v_exp_f32 v230, v230
    v_exp_f32 v231, v231
    v_exp_f32 v240, v240
    v_exp_f32 v241, v241
    v_exp_f32 v242, v242
    v_exp_f32 v243, v243
    v_exp_f32 v252, v252
    v_exp_f32 v253, v253
    v_exp_f32 v254, v254
    v_exp_f32 v255, v255
    v_exp_f32 v88, v88
    v_exp_f32 v89, v89
    v_exp_f32 v90, v90
    v_exp_f32 v91, v91
    v_cvt_pk_bf16_f32 v228, v228, v229
    v_cvt_pk_bf16_f32 v229, v230, v231
    v_cvt_pk_bf16_f32 v230, v240, v241
    v_cvt_pk_bf16_f32 v231, v242, v243
    v_cvt_pk_bf16_f32 v252, v252, v253
    v_cvt_pk_bf16_f32 v253, v254, v255
    v_cvt_pk_bf16_f32 v254, v88, v89
    v_cvt_pk_bf16_f32 v255, v90, v91
    v_fma_f32 v232, v232, s13, -v126
    v_fma_f32 v233, v233, s13, -v126
    v_fma_f32 v234, v234, s13, -v126
    v_fma_f32 v235, v235, s13, -v126
    v_fma_f32 v244, v244, s13, -v126
    v_fma_f32 v245, v245, s13, -v126
    v_fma_f32 v246, v246, s13, -v126
    v_fma_f32 v247, v247, s13, -v126
    v_fma_f32 v80, v80, s13, -v126
    v_fma_f32 v81, v81, s13, -v126
    v_fma_f32 v82, v82, s13, -v126
    v_fma_f32 v83, v83, s13, -v126
    v_fma_f32 v12, v12, s13, -v126
    v_fma_f32 v13, v13, s13, -v126
    v_fma_f32 v14, v14, s13, -v126
    v_fma_f32 v15, v15, s13, -v126
    v_exp_f32 v232, v232
    v_exp_f32 v233, v233
    v_exp_f32 v234, v234
    v_exp_f32 v235, v235
    v_exp_f32 v244, v244
    v_exp_f32 v245, v245
    v_exp_f32 v246, v246
    v_exp_f32 v247, v247
    v_exp_f32 v80, v80
    v_exp_f32 v81, v81
    v_exp_f32 v82, v82
    v_exp_f32 v83, v83
    v_exp_f32 v12, v12
    v_exp_f32 v13, v13
    v_exp_f32 v14, v14
    v_exp_f32 v15, v15
    v_cvt_pk_bf16_f32 v232, v232, v233
    v_cvt_pk_bf16_f32 v233, v234, v235
    v_cvt_pk_bf16_f32 v234, v244, v245
    v_cvt_pk_bf16_f32 v235, v246, v247
    v_cvt_pk_bf16_f32 v80, v80, v81
    v_cvt_pk_bf16_f32 v81, v82, v83
    v_cvt_pk_bf16_f32 v82, v12, v13
    v_cvt_pk_bf16_f32 v83, v14, v15
    ds_read_b64_tr_b16 v[76:77], v103
    ds_read_b64_tr_b16 v[78:79], v103 offset:4096
    s_waitcnt lgkmcnt(6)
    v_mfma_f32_16x16x32_bf16 v[128:131], v[64:67], v[224:227], 0
    v_mfma_f32_16x16x32_bf16 v[132:135], v[64:67], v[228:231], 0
    v_mfma_f32_16x16x32_bf16 v[136:139], v[64:67], v[232:235], 0
    v_mfma_f32_16x16x32_bf16 v[2:5], v[116:119], v[224:227], 0
    v_mfma_f32_16x16x32_bf16 v[8:11], v[116:119], v[228:231], 0
    v_mfma_f32_16x16x32_bf16 v[120:123], v[116:119], v[232:235], 0
    ds_read_b64_tr_b16 v[64:65], v104
    ds_read_b64_tr_b16 v[66:67], v104 offset:4096
    s_waitcnt lgkmcnt(6)
    v_mfma_f32_16x16x32_bf16 v[140:143], v[68:71], v[224:227], 0
    v_mfma_f32_16x16x32_bf16 v[144:147], v[68:71], v[228:231], 0
    v_mfma_f32_16x16x32_bf16 v[148:151], v[68:71], v[232:235], 0
    ds_read_b64_tr_b16 v[68:69], v105
    ds_read_b64_tr_b16 v[70:71], v105 offset:4096
    s_waitcnt lgkmcnt(6)
    v_mfma_f32_16x16x32_bf16 v[152:155], v[72:75], v[224:227], 0
    v_mfma_f32_16x16x32_bf16 v[156:159], v[72:75], v[228:231], 0
    v_mfma_f32_16x16x32_bf16 v[160:163], v[72:75], v[232:235], 0
    ds_read_b64_tr_b16 v[72:73], v106
    ds_read_b64_tr_b16 v[74:75], v106 offset:4096
    s_waitcnt lgkmcnt(6)
    v_mfma_f32_16x16x32_bf16 v[164:167], v[76:79], v[224:227], 0
    v_mfma_f32_16x16x32_bf16 v[168:171], v[76:79], v[228:231], 0
    v_mfma_f32_16x16x32_bf16 v[172:175], v[76:79], v[232:235], 0
    ds_read_b64_tr_b16 v[76:77], v107
    ds_read_b64_tr_b16 v[78:79], v107 offset:4096
    s_waitcnt lgkmcnt(6)
    v_mfma_f32_16x16x32_bf16 v[176:179], v[64:67], v[224:227], 0
    v_mfma_f32_16x16x32_bf16 v[180:183], v[64:67], v[228:231], 0
    v_mfma_f32_16x16x32_bf16 v[184:187], v[64:67], v[232:235], 0
    ds_read_b64_tr_b16 v[64:65], v100 offset:8192
    ds_read_b64_tr_b16 v[66:67], v100 offset:12288
    s_waitcnt lgkmcnt(6)
    v_mfma_f32_16x16x32_bf16 v[188:191], v[68:71], v[224:227], 0
    v_mfma_f32_16x16x32_bf16 v[192:195], v[68:71], v[228:231], 0
    v_mfma_f32_16x16x32_bf16 v[196:199], v[68:71], v[232:235], 0
    ds_read_b64_tr_b16 v[68:69], v101 offset:8192
    ds_read_b64_tr_b16 v[70:71], v101 offset:12288
    s_waitcnt lgkmcnt(6)
    v_mfma_f32_16x16x32_bf16 v[200:203], v[72:75], v[224:227], 0
    v_mfma_f32_16x16x32_bf16 v[204:207], v[72:75], v[228:231], 0
    v_mfma_f32_16x16x32_bf16 v[208:211], v[72:75], v[232:235], 0
    ds_read_b64_tr_b16 v[72:73], v102 offset:8192
    ds_read_b64_tr_b16 v[74:75], v102 offset:12288
    s_waitcnt lgkmcnt(6)
    v_mfma_f32_16x16x32_bf16 v[212:215], v[76:79], v[224:227], 0
    v_mfma_f32_16x16x32_bf16 v[216:219], v[76:79], v[228:231], 0
    v_mfma_f32_16x16x32_bf16 v[220:223], v[76:79], v[232:235], 0
    ds_read_b64_tr_b16 v[76:77], v103 offset:8192
    ds_read_b64_tr_b16 v[78:79], v103 offset:12288
    s_waitcnt lgkmcnt(6)
    v_mfma_f32_16x16x32_bf16 v[128:131], v[64:67], v[248:251], v[128:131]
    v_mfma_f32_16x16x32_bf16 v[132:135], v[64:67], v[252:255], v[132:135]
    v_mfma_f32_16x16x32_bf16 v[136:139], v[64:67], v[80:83], v[136:139]
    v_mfma_f32_16x16x32_bf16 v[2:5], v[116:119], v[248:251], v[2:5]
    v_mfma_f32_16x16x32_bf16 v[8:11], v[116:119], v[252:255], v[8:11]
    v_mfma_f32_16x16x32_bf16 v[120:123], v[116:119], v[80:83], v[120:123]
    ds_read_b64_tr_b16 v[64:65], v104 offset:8192
    ds_read_b64_tr_b16 v[66:67], v104 offset:12288
    s_waitcnt lgkmcnt(6)
    v_mfma_f32_16x16x32_bf16 v[140:143], v[68:71], v[248:251], v[140:143]
    v_mfma_f32_16x16x32_bf16 v[144:147], v[68:71], v[252:255], v[144:147]
    v_mfma_f32_16x16x32_bf16 v[148:151], v[68:71], v[80:83], v[148:151]
    ds_read_b64_tr_b16 v[68:69], v105 offset:8192
    ds_read_b64_tr_b16 v[70:71], v105 offset:12288
    s_waitcnt lgkmcnt(6)
    v_mfma_f32_16x16x32_bf16 v[152:155], v[72:75], v[248:251], v[152:155]
    v_mfma_f32_16x16x32_bf16 v[156:159], v[72:75], v[252:255], v[156:159]
    v_mfma_f32_16x16x32_bf16 v[160:163], v[72:75], v[80:83], v[160:163]
    ds_read_b64_tr_b16 v[72:73], v106 offset:8192
    ds_read_b64_tr_b16 v[74:75], v106 offset:12288
    s_waitcnt lgkmcnt(6)
    v_mfma_f32_16x16x32_bf16 v[164:167], v[76:79], v[248:251], v[164:167]
    v_mfma_f32_16x16x32_bf16 v[168:171], v[76:79], v[252:255], v[168:171]
    v_mfma_f32_16x16x32_bf16 v[172:175], v[76:79], v[80:83], v[172:175]
    ds_read_b64_tr_b16 v[76:77], v107 offset:8192
    ds_read_b64_tr_b16 v[78:79], v107 offset:12288
    s_waitcnt lgkmcnt(6)
    v_mfma_f32_16x16x32_bf16 v[176:179], v[64:67], v[248:251], v[176:179]
    v_mfma_f32_16x16x32_bf16 v[180:183], v[64:67], v[252:255], v[180:183]
    v_mfma_f32_16x16x32_bf16 v[184:187], v[64:67], v[80:83], v[184:187]
    s_waitcnt lgkmcnt(4)
    v_mfma_f32_16x16x32_bf16 v[188:191], v[68:71], v[248:251], v[188:191]
    v_mfma_f32_16x16x32_bf16 v[192:195], v[68:71], v[252:255], v[192:195]
    v_mfma_f32_16x16x32_bf16 v[196:199], v[68:71], v[80:83], v[196:199]
    s_waitcnt lgkmcnt(2)
    v_mfma_f32_16x16x32_bf16 v[200:203], v[72:75], v[248:251], v[200:203]
    v_mfma_f32_16x16x32_bf16 v[204:207], v[72:75], v[252:255], v[204:207]
    v_mfma_f32_16x16x32_bf16 v[208:211], v[72:75], v[80:83], v[208:211]
    s_waitcnt lgkmcnt(0)
    v_mfma_f32_16x16x32_bf16 v[212:215], v[76:79], v[248:251], v[212:215]
    v_mfma_f32_16x16x32_bf16 v[216:219], v[76:79], v[252:255], v[216:219]
    v_mfma_f32_16x16x32_bf16 v[220:223], v[76:79], v[80:83], v[220:223]
    v_xor_b32 v96, 65536, v96
    v_xor_b32 v97, 65536, v97
    v_xor_b32 v98, 65536, v98
    v_xor_b32 v99, 65536, v99
    v_xor_b32 v100, 65536, v100
    v_xor_b32 v101, 65536, v101
    v_xor_b32 v102, 65536, v102
    v_xor_b32 v103, 65536, v103
    v_xor_b32 v104, 65536, v104
    v_xor_b32 v105, 65536, v105
    v_xor_b32 v106, 65536, v106
    v_xor_b32 v107, 65536, v107
    s_waitcnt vmcnt(0)
    s_barrier
    ds_read_b128 v[64:67], v96
    ds_read_b128 v[68:71], v97
    ds_read_b128 v[72:75], v98
    ds_read_b128 v[76:79], v99
    s_waitcnt lgkmcnt(3)
    v_mfma_f32_16x16x32_bf16 v[224:227], v[64:67], v[16:19], 0
    v_mfma_f32_16x16x32_bf16 v[228:231], v[64:67], v[32:35], 0
    v_mfma_f32_16x16x32_bf16 v[232:235], v[64:67], v[48:51], 0
    ds_read_b128 v[64:67], v96 offset:4096
    s_add_u32 m0, s9, 0
    s_add_u32 s14, s15, 32768
    buffer_load_dwordx4 v92, s[52:55], s14 offen nt lds
    s_waitcnt lgkmcnt(3)
    v_mfma_f32_16x16x32_bf16 v[224:227], v[68:71], v[20:23], v[224:227]
    v_mfma_f32_16x16x32_bf16 v[228:231], v[68:71], v[36:39], v[228:231]
    v_mfma_f32_16x16x32_bf16 v[232:235], v[68:71], v[52:55], v[232:235]
    ds_read_b128 v[68:71], v97 offset:4096
    s_waitcnt lgkmcnt(3)
    v_mfma_f32_16x16x32_bf16 v[224:227], v[72:75], v[24:27], v[224:227]
    v_mfma_f32_16x16x32_bf16 v[228:231], v[72:75], v[40:43], v[228:231]
    v_mfma_f32_16x16x32_bf16 v[232:235], v[72:75], v[56:59], v[232:235]
    ds_read_b128 v[72:75], v98 offset:4096
    s_add_u32 m0, s9, 1024
    s_add_u32 s14, s15, 33792
    buffer_load_dwordx4 v93, s[52:55], s14 offen nt lds
    s_waitcnt lgkmcnt(3)
    v_mfma_f32_16x16x32_bf16 v[224:227], v[76:79], v[28:31], v[224:227]
    v_mfma_f32_16x16x32_bf16 v[228:231], v[76:79], v[44:47], v[228:231]
    v_mfma_f32_16x16x32_bf16 v[232:235], v[76:79], v[60:63], v[232:235]
    ds_read_b128 v[76:79], v99 offset:4096
    s_waitcnt lgkmcnt(3)
    v_mfma_f32_16x16x32_bf16 v[236:239], v[64:67], v[16:19], 0
    v_mfma_f32_16x16x32_bf16 v[240:243], v[64:67], v[32:35], 0
    v_mfma_f32_16x16x32_bf16 v[244:247], v[64:67], v[48:51], 0
    ds_read_b128 v[64:67], v96 offset:8192
    s_add_u32 m0, s9, 2048
    s_add_u32 s14, s15, 34816
    buffer_load_dwordx4 v94, s[52:55], s14 offen nt lds
    s_waitcnt lgkmcnt(3)
    v_mfma_f32_16x16x32_bf16 v[236:239], v[68:71], v[20:23], v[236:239]
    v_mfma_f32_16x16x32_bf16 v[240:243], v[68:71], v[36:39], v[240:243]
    v_mfma_f32_16x16x32_bf16 v[244:247], v[68:71], v[52:55], v[244:247]
    ds_read_b128 v[68:71], v97 offset:8192
    s_waitcnt lgkmcnt(3)
    v_mfma_f32_16x16x32_bf16 v[236:239], v[72:75], v[24:27], v[236:239]
    v_mfma_f32_16x16x32_bf16 v[240:243], v[72:75], v[40:43], v[240:243]
    v_mfma_f32_16x16x32_bf16 v[244:247], v[72:75], v[56:59], v[244:247]
    ds_read_b128 v[72:75], v98 offset:8192
    s_add_u32 m0, s9, 3072
    s_add_u32 s14, s15, 35840
    buffer_load_dwordx4 v95, s[52:55], s14 offen nt lds
    s_waitcnt lgkmcnt(3)
    v_mfma_f32_16x16x32_bf16 v[236:239], v[76:79], v[28:31], v[236:239]
    v_mfma_f32_16x16x32_bf16 v[240:243], v[76:79], v[44:47], v[240:243]
    v_mfma_f32_16x16x32_bf16 v[244:247], v[76:79], v[60:63], v[244:247]
    ds_read_b128 v[76:79], v99 offset:8192
    s_waitcnt lgkmcnt(3)
    v_mfma_f32_16x16x32_bf16 v[248:251], v[64:67], v[16:19], 0
    v_mfma_f32_16x16x32_bf16 v[252:255], v[64:67], v[32:35], 0
    v_mfma_f32_16x16x32_bf16 v[80:83], v[64:67], v[48:51], 0
    ds_read_b128 v[64:67], v96 offset:12288
    s_add_u32 m0, s9, 4096
    s_add_u32 s14, s15, 36864
    buffer_load_dwordx4 v92, s[52:55], s14 offen nt lds
    s_waitcnt lgkmcnt(3)
    v_mfma_f32_16x16x32_bf16 v[248:251], v[68:71], v[20:23], v[248:251]
    v_mfma_f32_16x16x32_bf16 v[252:255], v[68:71], v[36:39], v[252:255]
    v_mfma_f32_16x16x32_bf16 v[80:83], v[68:71], v[52:55], v[80:83]
    ds_read_b128 v[68:71], v97 offset:12288
    s_waitcnt lgkmcnt(3)
    v_mfma_f32_16x16x32_bf16 v[248:251], v[72:75], v[24:27], v[248:251]
    v_mfma_f32_16x16x32_bf16 v[252:255], v[72:75], v[40:43], v[252:255]
    v_mfma_f32_16x16x32_bf16 v[80:83], v[72:75], v[56:59], v[80:83]
    ds_read_b128 v[72:75], v98 offset:12288
    s_add_u32 m0, s9, 5120
    s_add_u32 s14, s15, 37888
    buffer_load_dwordx4 v93, s[52:55], s14 offen nt lds
    s_waitcnt lgkmcnt(3)
    v_mfma_f32_16x16x32_bf16 v[248:251], v[76:79], v[28:31], v[248:251]
    v_mfma_f32_16x16x32_bf16 v[252:255], v[76:79], v[44:47], v[252:255]
    v_mfma_f32_16x16x32_bf16 v[80:83], v[76:79], v[60:63], v[80:83]
    ds_read_b128 v[76:79], v99 offset:12288
    s_waitcnt lgkmcnt(3)
    v_mfma_f32_16x16x32_bf16 v[84:87], v[64:67], v[16:19], 0
    v_mfma_f32_16x16x32_bf16 v[88:91], v[64:67], v[32:35], 0
    v_mfma_f32_16x16x32_bf16 v[12:15], v[64:67], v[48:51], 0
    s_add_u32 m0, s9, 6144
    s_add_u32 s14, s15, 38912
    buffer_load_dwordx4 v94, s[52:55], s14 offen nt lds
    s_waitcnt lgkmcnt(2)
    v_mfma_f32_16x16x32_bf16 v[84:87], v[68:71], v[20:23], v[84:87]
    v_mfma_f32_16x16x32_bf16 v[88:91], v[68:71], v[36:39], v[88:91]
    v_mfma_f32_16x16x32_bf16 v[12:15], v[68:71], v[52:55], v[12:15]
    s_waitcnt lgkmcnt(1)
    v_mfma_f32_16x16x32_bf16 v[84:87], v[72:75], v[24:27], v[84:87]
    v_mfma_f32_16x16x32_bf16 v[88:91], v[72:75], v[40:43], v[88:91]
    v_mfma_f32_16x16x32_bf16 v[12:15], v[72:75], v[56:59], v[12:15]
    s_add_u32 m0, s9, 7168
    s_add_u32 s14, s15, 39936
    buffer_load_dwordx4 v95, s[52:55], s14 offen nt lds
    s_waitcnt lgkmcnt(0)
    v_mfma_f32_16x16x32_bf16 v[84:87], v[76:79], v[28:31], v[84:87]
    v_mfma_f32_16x16x32_bf16 v[88:91], v[76:79], v[44:47], v[88:91]
    v_mfma_f32_16x16x32_bf16 v[12:15], v[76:79], v[60:63], v[12:15]
    ds_read_b64_tr_b16 v[64:65], v100
    ds_read_b64_tr_b16 v[66:67], v100 offset:4096
    ds_read_b64_tr_b16 v[68:69], v101
    ds_read_b64_tr_b16 v[70:71], v101 offset:4096
    ds_read_b64_tr_b16 v[72:73], v102
    ds_read_b64_tr_b16 v[74:75], v102 offset:4096
    v_max3_f32 v124, v224, v225, v226
    v_max3_f32 v124, v124, v227, v236
    v_max3_f32 v124, v124, v237, v238
    v_max3_f32 v124, v124, v239, v248
    v_max3_f32 v124, v124, v249, v250
    v_max3_f32 v124, v124, v251, v84
    v_max3_f32 v124, v124, v85, v86
    v_max_f32 v124, v124, v87
    v_max3_f32 v125, v228, v229, v230
    v_max3_f32 v125, v125, v231, v240
    v_max3_f32 v125, v125, v241, v242
    v_max3_f32 v125, v125, v243, v252
    v_max3_f32 v125, v125, v253, v254
    v_max3_f32 v125, v125, v255, v88
    v_max3_f32 v125, v125, v89, v90
    v_max_f32 v125, v125, v91
    v_max3_f32 v126, v232, v233, v234
    v_max3_f32 v126, v126, v235, v244
    v_max3_f32 v126, v126, v245, v246
    v_max3_f32 v126, v126, v247, v80
    v_max3_f32 v126, v126, v81, v82
    v_max3_f32 v126, v126, v83, v12
    v_max3_f32 v126, v126, v13, v14
    v_max_f32 v126, v126, v15
    v_mov_b32 v127, v124
    v_mov_b32 v114, v125
    v_mov_b32 v115, v126
    v_permlane32_swap_b32 v124, v127
    v_permlane32_swap_b32 v125, v114
    v_permlane32_swap_b32 v126, v115
    v_max_f32 v124, v124, v127
    v_max_f32 v125, v125, v114
    v_max_f32 v126, v126, v115
    v_mov_b32 v127, v124
    v_mov_b32 v114, v125
    v_mov_b32 v115, v126
    v_permlane16_swap_b32 v124, v127
    v_permlane16_swap_b32 v125, v114
    v_permlane16_swap_b32 v126, v115
    v_max_f32 v124, v124, v127
    v_max_f32 v125, v125, v114
    v_max_f32 v126, v126, v115
    v_sub_f32 v127, v124, v108
    v_sub_f32 v114, v125, v109
    v_sub_f32 v115, v126, v110
    v_max3_f32 v127, v127, v114, v115
    v_cmp_lt_f32 vcc, s62, v127
    s_nop 3
    s_cbranch_vccz L_16
    v_max_f32 v124, v124, v108
    v_sub_f32 v111, v108, v124
    v_mul_f32 v111, s13, v111
    v_exp_f32 v111, v111
    v_mov_b32 v108, v124
    v_max_f32 v125, v125, v109
    v_sub_f32 v112, v109, v125
    v_mul_f32 v112, s13, v112
    v_exp_f32 v112, v112
    v_mov_b32 v109, v125
    v_max_f32 v126, v126, v110
    v_sub_f32 v113, v110, v126
    v_mul_f32 v113, s13, v113
    v_exp_f32 v113, v113
    v_mov_b32 v110, v126
    v_mul_f32 v128, v128, v111
    v_mul_f32 v129, v129, v111
    v_mul_f32 v130, v130, v111
    v_mul_f32 v131, v131, v111
    v_mul_f32 v132, v132, v112
    v_mul_f32 v133, v133, v112
    v_mul_f32 v134, v134, v112
    v_mul_f32 v135, v135, v112
    v_mul_f32 v136, v136, v113
    v_mul_f32 v137, v137, v113
    v_mul_f32 v138, v138, v113
    v_mul_f32 v139, v139, v113
    v_mul_f32 v140, v140, v111
    v_mul_f32 v141, v141, v111
    v_mul_f32 v142, v142, v111
    v_mul_f32 v143, v143, v111
    v_mul_f32 v144, v144, v112
    v_mul_f32 v145, v145, v112
    v_mul_f32 v146, v146, v112
    v_mul_f32 v147, v147, v112
    v_mul_f32 v148, v148, v113
    v_mul_f32 v149, v149, v113
    v_mul_f32 v150, v150, v113
    v_mul_f32 v151, v151, v113
    v_mul_f32 v152, v152, v111
    v_mul_f32 v153, v153, v111
    v_mul_f32 v154, v154, v111
    v_mul_f32 v155, v155, v111
    v_mul_f32 v156, v156, v112
    v_mul_f32 v157, v157, v112
    v_mul_f32 v158, v158, v112
    v_mul_f32 v159, v159, v112
    v_mul_f32 v160, v160, v113
    v_mul_f32 v161, v161, v113
    v_mul_f32 v162, v162, v113
    v_mul_f32 v163, v163, v113
    v_mul_f32 v164, v164, v111
    v_mul_f32 v165, v165, v111
    v_mul_f32 v166, v166, v111
    v_mul_f32 v167, v167, v111
    v_mul_f32 v168, v168, v112
    v_mul_f32 v169, v169, v112
    v_mul_f32 v170, v170, v112
    v_mul_f32 v171, v171, v112
    v_mul_f32 v172, v172, v113
    v_mul_f32 v173, v173, v113
    v_mul_f32 v174, v174, v113
    v_mul_f32 v175, v175, v113
    v_mul_f32 v176, v176, v111
    v_mul_f32 v177, v177, v111
    v_mul_f32 v178, v178, v111
    v_mul_f32 v179, v179, v111
    v_mul_f32 v180, v180, v112
    v_mul_f32 v181, v181, v112
    v_mul_f32 v182, v182, v112
    v_mul_f32 v183, v183, v112
    v_mul_f32 v184, v184, v113
    v_mul_f32 v185, v185, v113
    v_mul_f32 v186, v186, v113
    v_mul_f32 v187, v187, v113
    v_mul_f32 v188, v188, v111
    v_mul_f32 v189, v189, v111
    v_mul_f32 v190, v190, v111
    v_mul_f32 v191, v191, v111
    v_mul_f32 v192, v192, v112
    v_mul_f32 v193, v193, v112
    v_mul_f32 v194, v194, v112
    v_mul_f32 v195, v195, v112
    v_mul_f32 v196, v196, v113
    v_mul_f32 v197, v197, v113
    v_mul_f32 v198, v198, v113
    v_mul_f32 v199, v199, v113
    v_mul_f32 v200, v200, v111
    v_mul_f32 v201, v201, v111
    v_mul_f32 v202, v202, v111
    v_mul_f32 v203, v203, v111
    v_mul_f32 v204, v204, v112
    v_mul_f32 v205, v205, v112
    v_mul_f32 v206, v206, v112
    v_mul_f32 v207, v207, v112
    v_mul_f32 v208, v208, v113
    v_mul_f32 v209, v209, v113
    v_mul_f32 v210, v210, v113
    v_mul_f32 v211, v211, v113
    v_mul_f32 v212, v212, v111
    v_mul_f32 v213, v213, v111
    v_mul_f32 v214, v214, v111
    v_mul_f32 v215, v215, v111
    v_mul_f32 v216, v216, v112
    v_mul_f32 v217, v217, v112
    v_mul_f32 v218, v218, v112
    v_mul_f32 v219, v219, v112
    v_mul_f32 v220, v220, v113
    v_mul_f32 v221, v221, v113
    v_mul_f32 v222, v222, v113
    v_mul_f32 v223, v223, v113
    v_mul_f32 v2, v2, v111
    v_mul_f32 v3, v3, v111
    v_mul_f32 v4, v4, v111
    v_mul_f32 v5, v5, v111
    v_mul_f32 v8, v8, v112
    v_mul_f32 v9, v9, v112
    v_mul_f32 v10, v10, v112
    v_mul_f32 v11, v11, v112
    v_mul_f32 v120, v120, v113
    v_mul_f32 v121, v121, v113
    v_mul_f32 v122, v122, v113
    v_mul_f32 v123, v123, v113
L_16:
    s_nop 1
    v_mul_f32 v124, s13, v108
    v_mul_f32 v125, s13, v109
    v_mul_f32 v126, s13, v110
    v_fma_f32 v224, v224, s13, -v124
    v_fma_f32 v225, v225, s13, -v124
    v_fma_f32 v226, v226, s13, -v124
    v_fma_f32 v227, v227, s13, -v124
    v_fma_f32 v236, v236, s13, -v124
    v_fma_f32 v237, v237, s13, -v124
    v_fma_f32 v238, v238, s13, -v124
    v_fma_f32 v239, v239, s13, -v124
    v_fma_f32 v248, v248, s13, -v124
    v_fma_f32 v249, v249, s13, -v124
    v_fma_f32 v250, v250, s13, -v124
    v_fma_f32 v251, v251, s13, -v124
    v_fma_f32 v84, v84, s13, -v124
    v_fma_f32 v85, v85, s13, -v124
    v_fma_f32 v86, v86, s13, -v124
    v_fma_f32 v87, v87, s13, -v124
    v_exp_f32 v224, v224
    v_exp_f32 v225, v225
    v_exp_f32 v226, v226
    v_exp_f32 v227, v227
    v_exp_f32 v236, v236
    v_exp_f32 v237, v237
    v_exp_f32 v238, v238
    v_exp_f32 v239, v239
    v_exp_f32 v248, v248
    v_exp_f32 v249, v249
    v_exp_f32 v250, v250
    v_exp_f32 v251, v251
    v_exp_f32 v84, v84
    v_exp_f32 v85, v85
    v_exp_f32 v86, v86
    v_exp_f32 v87, v87
    v_cvt_pk_bf16_f32 v224, v224, v225
    v_cvt_pk_bf16_f32 v225, v226, v227
    v_cvt_pk_bf16_f32 v226, v236, v237
    v_cvt_pk_bf16_f32 v227, v238, v239
    v_cvt_pk_bf16_f32 v248, v248, v249
    v_cvt_pk_bf16_f32 v249, v250, v251
    v_cvt_pk_bf16_f32 v250, v84, v85
    v_cvt_pk_bf16_f32 v251, v86, v87
    v_fma_f32 v228, v228, s13, -v125
    v_fma_f32 v229, v229, s13, -v125
    v_fma_f32 v230, v230, s13, -v125
    v_fma_f32 v231, v231, s13, -v125
    v_fma_f32 v240, v240, s13, -v125
    v_fma_f32 v241, v241, s13, -v125
    v_fma_f32 v242, v242, s13, -v125
    v_fma_f32 v243, v243, s13, -v125
    v_fma_f32 v252, v252, s13, -v125
    v_fma_f32 v253, v253, s13, -v125
    v_fma_f32 v254, v254, s13, -v125
    v_fma_f32 v255, v255, s13, -v125
    v_fma_f32 v88, v88, s13, -v125
    v_fma_f32 v89, v89, s13, -v125
    v_fma_f32 v90, v90, s13, -v125
    v_fma_f32 v91, v91, s13, -v125
    v_exp_f32 v228, v228
    v_exp_f32 v229, v229
    v_exp_f32 v230, v230
    v_exp_f32 v231, v231
    v_exp_f32 v240, v240
    v_exp_f32 v241, v241
    v_exp_f32 v242, v242
    v_exp_f32 v243, v243
    v_exp_f32 v252, v252
    v_exp_f32 v253, v253
    v_exp_f32 v254, v254
    v_exp_f32 v255, v255
    v_exp_f32 v88, v88
    v_exp_f32 v89, v89
    v_exp_f32 v90, v90
    v_exp_f32 v91, v91
    v_cvt_pk_bf16_f32 v228, v228, v229
    v_cvt_pk_bf16_f32 v229, v230, v231
    v_cvt_pk_bf16_f32 v230, v240, v241
    v_cvt_pk_bf16_f32 v231, v242, v243
    v_cvt_pk_bf16_f32 v252, v252, v253
    v_cvt_pk_bf16_f32 v253, v254, v255
    v_cvt_pk_bf16_f32 v254, v88, v89
    v_cvt_pk_bf16_f32 v255, v90, v91
    v_fma_f32 v232, v232, s13, -v126
    v_fma_f32 v233, v233, s13, -v126
    v_fma_f32 v234, v234, s13, -v126
    v_fma_f32 v235, v235, s13, -v126
    v_fma_f32 v244, v244, s13, -v126
    v_fma_f32 v245, v245, s13, -v126
    v_fma_f32 v246, v246, s13, -v126
    v_fma_f32 v247, v247, s13, -v126
    v_fma_f32 v80, v80, s13, -v126
    v_fma_f32 v81, v81, s13, -v126
    v_fma_f32 v82, v82, s13, -v126
    v_fma_f32 v83, v83, s13, -v126
    v_fma_f32 v12, v12, s13, -v126
    v_fma_f32 v13, v13, s13, -v126
    v_fma_f32 v14, v14, s13, -v126
    v_fma_f32 v15, v15, s13, -v126
    v_exp_f32 v232, v232
    v_exp_f32 v233, v233
    v_exp_f32 v234, v234
    v_exp_f32 v235, v235
    v_exp_f32 v244, v244
    v_exp_f32 v245, v245
    v_exp_f32 v246, v246
    v_exp_f32 v247, v247
    v_exp_f32 v80, v80
    v_exp_f32 v81, v81
    v_exp_f32 v82, v82
    v_exp_f32 v83, v83
    v_exp_f32 v12, v12
    v_exp_f32 v13, v13
    v_exp_f32 v14, v14
    v_exp_f32 v15, v15
    v_cvt_pk_bf16_f32 v232, v232, v233
    v_cvt_pk_bf16_f32 v233, v234, v235
    v_cvt_pk_bf16_f32 v234, v244, v245
    v_cvt_pk_bf16_f32 v235, v246, v247
    v_cvt_pk_bf16_f32 v80, v80, v81
    v_cvt_pk_bf16_f32 v81, v82, v83
    v_cvt_pk_bf16_f32 v82, v12, v13
    v_cvt_pk_bf16_f32 v83, v14, v15
    ds_read_b64_tr_b16 v[76:77], v103
    ds_read_b64_tr_b16 v[78:79], v103 offset:4096
    s_waitcnt lgkmcnt(6)
    v_mfma_f32_16x16x32_bf16 v[128:131], v[64:67], v[224:227], v[128:131]
    v_mfma_f32_16x16x32_bf16 v[132:135], v[64:67], v[228:231], v[132:135]
    v_mfma_f32_16x16x32_bf16 v[136:139], v[64:67], v[232:235], v[136:139]
    v_mfma_f32_16x16x32_bf16 v[2:5], v[116:119], v[224:227], v[2:5]
    v_mfma_f32_16x16x32_bf16 v[8:11], v[116:119], v[228:231], v[8:11]
    v_mfma_f32_16x16x32_bf16 v[120:123], v[116:119], v[232:235], v[120:123]
    ds_read_b64_tr_b16 v[64:65], v104
    ds_read_b64_tr_b16 v[66:67], v104 offset:4096
    s_waitcnt lgkmcnt(6)
    v_mfma_f32_16x16x32_bf16 v[140:143], v[68:71], v[224:227], v[140:143]
    v_mfma_f32_16x16x32_bf16 v[144:147], v[68:71], v[228:231], v[144:147]
    v_mfma_f32_16x16x32_bf16 v[148:151], v[68:71], v[232:235], v[148:151]
    ds_read_b64_tr_b16 v[68:69], v105
    ds_read_b64_tr_b16 v[70:71], v105 offset:4096
    s_waitcnt lgkmcnt(6)
    v_mfma_f32_16x16x32_bf16 v[152:155], v[72:75], v[224:227], v[152:155]
    v_mfma_f32_16x16x32_bf16 v[156:159], v[72:75], v[228:231], v[156:159]
    v_mfma_f32_16x16x32_bf16 v[160:163], v[72:75], v[232:235], v[160:163]
    ds_read_b64_tr_b16 v[72:73], v106
    ds_read_b64_tr_b16 v[74:75], v106 offset:4096
    s_waitcnt lgkmcnt(6)
    v_mfma_f32_16x16x32_bf16 v[164:167], v[76:79], v[224:227], v[164:167]
    v_mfma_f32_16x16x32_bf16 v[168:171], v[76:79], v[228:231], v[168:171]
    v_mfma_f32_16x16x32_bf16 v[172:175], v[76:79], v[232:235], v[172:175]
    ds_read_b64_tr_b16 v[76:77], v107
    ds_read_b64_tr_b16 v[78:79], v107 offset:4096
    s_waitcnt lgkmcnt(6)
    v_mfma_f32_16x16x32_bf16 v[176:179], v[64:67], v[224:227], v[176:179]
    v_mfma_f32_16x16x32_bf16 v[180:183], v[64:67], v[228:231], v[180:183]
    v_mfma_f32_16x16x32_bf16 v[184:187], v[64:67], v[232:235], v[184:187]
    ds_read_b64_tr_b16 v[64:65], v100 offset:8192
    ds_read_b64_tr_b16 v[66:67], v100 offset:12288
    s_waitcnt lgkmcnt(6)
    v_mfma_f32_16x16x32_bf16 v[188:191], v[68:71], v[224:227], v[188:191]
    v_mfma_f32_16x16x32_bf16 v[192:195], v[68:71], v[228:231], v[192:195]
    v_mfma_f32_16x16x32_bf16 v[196:199], v[68:71], v[232:235], v[196:199]
    ds_read_b64_tr_b16 v[68:69], v101 offset:8192
    ds_read_b64_tr_b16 v[70:71], v101 offset:12288
    s_waitcnt lgkmcnt(6)
    v_mfma_f32_16x16x32_bf16 v[200:203], v[72:75], v[224:227], v[200:203]
    v_mfma_f32_16x16x32_bf16 v[204:207], v[72:75], v[228:231], v[204:207]
    v_mfma_f32_16x16x32_bf16 v[208:211], v[72:75], v[232:235], v[208:211]
    ds_read_b64_tr_b16 v[72:73], v102 offset:8192
    ds_read_b64_tr_b16 v[74:75], v102 offset:12288
    s_waitcnt lgkmcnt(6)
    v_mfma_f32_16x16x32_bf16 v[212:215], v[76:79], v[224:227], v[212:215]
    v_mfma_f32_16x16x32_bf16 v[216:219], v[76:79], v[228:231], v[216:219]
    v_mfma_f32_16x16x32_bf16 v[220:223], v[76:79], v[232:235], v[220:223]
    ds_read_b64_tr_b16 v[76:77], v103 offset:8192
    ds_read_b64_tr_b16 v[78:79], v103 offset:12288
    s_waitcnt lgkmcnt(6)
    v_mfma_f32_16x16x32_bf16 v[128:131], v[64:67], v[248:251], v[128:131]
    v_mfma_f32_16x16x32_bf16 v[132:135], v[64:67], v[252:255], v[132:135]
    v_mfma_f32_16x16x32_bf16 v[136:139], v[64:67], v[80:83], v[136:139]
    v_mfma_f32_16x16x32_bf16 v[2:5], v[116:119], v[248:251], v[2:5]
    v_mfma_f32_16x16x32_bf16 v[8:11], v[116:119], v[252:255], v[8:11]
    v_mfma_f32_16x16x32_bf16 v[120:123], v[116:119], v[80:83], v[120:123]
    ds_read_b64_tr_b16 v[64:65], v104 offset:8192
    ds_read_b64_tr_b16 v[66:67], v104 offset:12288
    s_waitcnt lgkmcnt(6)
    v_mfma_f32_16x16x32_bf16 v[140:143], v[68:71], v[248:251], v[140:143]
    v_mfma_f32_16x16x32_bf16 v[144:147], v[68:71], v[252:255], v[144:147]
    v_mfma_f32_16x16x32_bf16 v[148:151], v[68:71], v[80:83], v[148:151]
    ds_read_b64_tr_b16 v[68:69], v105 offset:8192
    ds_read_b64_tr_b16 v[70:71], v105 offset:12288
    s_waitcnt lgkmcnt(6)
    v_mfma_f32_16x16x32_bf16 v[152:155], v[72:75], v[248:251], v[152:155]
    v_mfma_f32_16x16x32_bf16 v[156:159], v[72:75], v[252:255], v[156:159]
    v_mfma_f32_16x16x32_bf16 v[160:163], v[72:75], v[80:83], v[160:163]
    ds_read_b64_tr_b16 v[72:73], v106 offset:8192
    ds_read_b64_tr_b16 v[74:75], v106 offset:12288
    s_waitcnt lgkmcnt(6)
    v_mfma_f32_16x16x32_bf16 v[164:167], v[76:79], v[248:251], v[164:167]
    v_mfma_f32_16x16x32_bf16 v[168:171], v[76:79], v[252:255], v[168:171]
    v_mfma_f32_16x16x32_bf16 v[172:175], v[76:79], v[80:83], v[172:175]
    ds_read_b64_tr_b16 v[76:77], v107 offset:8192
    ds_read_b64_tr_b16 v[78:79], v107 offset:12288
    s_waitcnt lgkmcnt(6)
    v_mfma_f32_16x16x32_bf16 v[176:179], v[64:67], v[248:251], v[176:179]
    v_mfma_f32_16x16x32_bf16 v[180:183], v[64:67], v[252:255], v[180:183]
    v_mfma_f32_16x16x32_bf16 v[184:187], v[64:67], v[80:83], v[184:187]
    s_waitcnt lgkmcnt(4)
    v_mfma_f32_16x16x32_bf16 v[188:191], v[68:71], v[248:251], v[188:191]
    v_mfma_f32_16x16x32_bf16 v[192:195], v[68:71], v[252:255], v[192:195]
    v_mfma_f32_16x16x32_bf16 v[196:199], v[68:71], v[80:83], v[196:199]
    s_waitcnt lgkmcnt(2)
    v_mfma_f32_16x16x32_bf16 v[200:203], v[72:75], v[248:251], v[200:203]
    v_mfma_f32_16x16x32_bf16 v[204:207], v[72:75], v[252:255], v[204:207]
    v_mfma_f32_16x16x32_bf16 v[208:211], v[72:75], v[80:83], v[208:211]
    s_waitcnt lgkmcnt(0)
    v_mfma_f32_16x16x32_bf16 v[212:215], v[76:79], v[248:251], v[212:215]
    v_mfma_f32_16x16x32_bf16 v[216:219], v[76:79], v[252:255], v[216:219]
    v_mfma_f32_16x16x32_bf16 v[220:223], v[76:79], v[80:83], v[220:223]
    v_xor_b32 v96, 65536, v96
    v_xor_b32 v97, 65536, v97
    v_xor_b32 v98, 65536, v98
    v_xor_b32 v99, 65536, v99
    v_xor_b32 v100, 65536, v100
    v_xor_b32 v101, 65536, v101
    v_xor_b32 v102, 65536, v102
    v_xor_b32 v103, 65536, v103
    v_xor_b32 v104, 65536, v104
    v_xor_b32 v105, 65536, v105
    v_xor_b32 v106, 65536, v106
    v_xor_b32 v107, 65536, v107
    s_waitcnt vmcnt(0)
    s_barrier
    ds_read_b128 v[64:67], v96
    ds_read_b128 v[68:71], v97
    ds_read_b128 v[72:75], v98
    ds_read_b128 v[76:79], v99
    s_waitcnt lgkmcnt(3)
    v_mfma_f32_16x16x32_bf16 v[224:227], v[64:67], v[16:19], 0
    v_mfma_f32_16x16x32_bf16 v[228:231], v[64:67], v[32:35], 0
    v_mfma_f32_16x16x32_bf16 v[232:235], v[64:67], v[48:51], 0
    ds_read_b128 v[64:67], v96 offset:4096
    s_add_u32 m0, s9, 65536
    s_add_u32 s14, s15, 49152
    buffer_load_dwordx4 v92, s[52:55], s14 offen nt lds
    s_waitcnt lgkmcnt(3)
    v_mfma_f32_16x16x32_bf16 v[224:227], v[68:71], v[20:23], v[224:227]
    v_mfma_f32_16x16x32_bf16 v[228:231], v[68:71], v[36:39], v[228:231]
    v_mfma_f32_16x16x32_bf16 v[232:235], v[68:71], v[52:55], v[232:235]
    ds_read_b128 v[68:71], v97 offset:4096
    s_waitcnt lgkmcnt(3)
    v_mfma_f32_16x16x32_bf16 v[224:227], v[72:75], v[24:27], v[224:227]
    v_mfma_f32_16x16x32_bf16 v[228:231], v[72:75], v[40:43], v[228:231]
    v_mfma_f32_16x16x32_bf16 v[232:235], v[72:75], v[56:59], v[232:235]
    ds_read_b128 v[72:75], v98 offset:4096
    s_add_u32 m0, s9, 66560
    s_add_u32 s14, s15, 50176
    buffer_load_dwordx4 v93, s[52:55], s14 offen nt lds
    s_waitcnt lgkmcnt(3)
    v_mfma_f32_16x16x32_bf16 v[224:227], v[76:79], v[28:31], v[224:227]
    v_mfma_f32_16x16x32_bf16 v[228:231], v[76:79], v[44:47], v[228:231]
    v_mfma_f32_16x16x32_bf16 v[232:235], v[76:79], v[60:63], v[232:235]
    ds_read_b128 v[76:79], v99 offset:4096
    s_waitcnt lgkmcnt(3)
    v_mfma_f32_16x16x32_bf16 v[236:239], v[64:67], v[16:19], 0
    v_mfma_f32_16x16x32_bf16 v[240:243], v[64:67], v[32:35], 0
    v_mfma_f32_16x16x32_bf16 v[244:247], v[64:67], v[48:51], 0
    ds_read_b128 v[64:67], v96 offset:8192
    s_add_u32 m0, s9, 67584
    s_add_u32 s14, s15, 51200
    buffer_load_dwordx4 v94, s[52:55], s14 offen nt lds
    s_waitcnt lgkmcnt(3)
    v_mfma_f32_16x16x32_bf16 v[236:239], v[68:71], v[20:23], v[236:239]
    v_mfma_f32_16x16x32_bf16 v[240:243], v[68:71], v[36:39], v[240:243]
    v_mfma_f32_16x16x32_bf16 v[244:247], v[68:71], v[52:55], v[244:247]
    ds_read_b128 v[68:71], v97 offset:8192
    s_waitcnt lgkmcnt(3)
    v_mfma_f32_16x16x32_bf16 v[236:239], v[72:75], v[24:27], v[236:239]
    v_mfma_f32_16x16x32_bf16 v[240:243], v[72:75], v[40:43], v[240:243]
    v_mfma_f32_16x16x32_bf16 v[244:247], v[72:75], v[56:59], v[244:247]
    ds_read_b128 v[72:75], v98 offset:8192
    s_add_u32 m0, s9, 68608
    s_add_u32 s14, s15, 52224
    buffer_load_dwordx4 v95, s[52:55], s14 offen nt lds
    s_waitcnt lgkmcnt(3)
    v_mfma_f32_16x16x32_bf16 v[236:239], v[76:79], v[28:31], v[236:239]
    v_mfma_f32_16x16x32_bf16 v[240:243], v[76:79], v[44:47], v[240:243]
    v_mfma_f32_16x16x32_bf16 v[244:247], v[76:79], v[60:63], v[244:247]
    ds_read_b128 v[76:79], v99 offset:8192
    s_waitcnt lgkmcnt(3)
    v_mfma_f32_16x16x32_bf16 v[248:251], v[64:67], v[16:19], 0
    v_mfma_f32_16x16x32_bf16 v[252:255], v[64:67], v[32:35], 0
    v_mfma_f32_16x16x32_bf16 v[80:83], v[64:67], v[48:51], 0
    ds_read_b128 v[64:67], v96 offset:12288
    s_add_u32 m0, s9, 69632
    s_add_u32 s14, s15, 53248
    buffer_load_dwordx4 v92, s[52:55], s14 offen nt lds
    s_waitcnt lgkmcnt(3)
    v_mfma_f32_16x16x32_bf16 v[248:251], v[68:71], v[20:23], v[248:251]
    v_mfma_f32_16x16x32_bf16 v[252:255], v[68:71], v[36:39], v[252:255]
    v_mfma_f32_16x16x32_bf16 v[80:83], v[68:71], v[52:55], v[80:83]
    ds_read_b128 v[68:71], v97 offset:12288
    s_waitcnt lgkmcnt(3)
    v_mfma_f32_16x16x32_bf16 v[248:251], v[72:75], v[24:27], v[248:251]
    v_mfma_f32_16x16x32_bf16 v[252:255], v[72:75], v[40:43], v[252:255]
    v_mfma_f32_16x16x32_bf16 v[80:83], v[72:75], v[56:59], v[80:83]
    ds_read_b128 v[72:75], v98 offset:12288
    s_add_u32 m0, s9, 70656
    s_add_u32 s14, s15, 54272
    buffer_load_dwordx4 v93, s[52:55], s14 offen nt lds
    s_waitcnt lgkmcnt(3)
    v_mfma_f32_16x16x32_bf16 v[248:251], v[76:79], v[28:31], v[248:251]
    v_mfma_f32_16x16x32_bf16 v[252:255], v[76:79], v[44:47], v[252:255]
    v_mfma_f32_16x16x32_bf16 v[80:83], v[76:79], v[60:63], v[80:83]
    ds_read_b128 v[76:79], v99 offset:12288
    s_waitcnt lgkmcnt(3)
    v_mfma_f32_16x16x32_bf16 v[84:87], v[64:67], v[16:19], 0
    v_mfma_f32_16x16x32_bf16 v[88:91], v[64:67], v[32:35], 0
    v_mfma_f32_16x16x32_bf16 v[12:15], v[64:67], v[48:51], 0
    s_add_u32 m0, s9, 71680
    s_add_u32 s14, s15, 55296
    buffer_load_dwordx4 v94, s[52:55], s14 offen nt lds
    s_waitcnt lgkmcnt(2)
    v_mfma_f32_16x16x32_bf16 v[84:87], v[68:71], v[20:23], v[84:87]
    v_mfma_f32_16x16x32_bf16 v[88:91], v[68:71], v[36:39], v[88:91]
    v_mfma_f32_16x16x32_bf16 v[12:15], v[68:71], v[52:55], v[12:15]
    s_waitcnt lgkmcnt(1)
    v_mfma_f32_16x16x32_bf16 v[84:87], v[72:75], v[24:27], v[84:87]
    v_mfma_f32_16x16x32_bf16 v[88:91], v[72:75], v[40:43], v[88:91]
    v_mfma_f32_16x16x32_bf16 v[12:15], v[72:75], v[56:59], v[12:15]
    s_add_u32 m0, s9, 72704
    s_add_u32 s14, s15, 56320
    buffer_load_dwordx4 v95, s[52:55], s14 offen nt lds
    s_waitcnt lgkmcnt(0)
    v_mfma_f32_16x16x32_bf16 v[84:87], v[76:79], v[28:31], v[84:87]
    v_mfma_f32_16x16x32_bf16 v[88:91], v[76:79], v[44:47], v[88:91]
    v_mfma_f32_16x16x32_bf16 v[12:15], v[76:79], v[60:63], v[12:15]
    ds_read_b64_tr_b16 v[64:65], v100
    ds_read_b64_tr_b16 v[66:67], v100 offset:4096
    ds_read_b64_tr_b16 v[68:69], v101
    ds_read_b64_tr_b16 v[70:71], v101 offset:4096
    ds_read_b64_tr_b16 v[72:73], v102
    ds_read_b64_tr_b16 v[74:75], v102 offset:4096
    v_max3_f32 v124, v224, v225, v226
    v_max3_f32 v124, v124, v227, v236
    v_max3_f32 v124, v124, v237, v238
    v_max3_f32 v124, v124, v239, v248
    v_max3_f32 v124, v124, v249, v250
    v_max3_f32 v124, v124, v251, v84
    v_max3_f32 v124, v124, v85, v86
    v_max_f32 v124, v124, v87
    v_max3_f32 v125, v228, v229, v230
    v_max3_f32 v125, v125, v231, v240
    v_max3_f32 v125, v125, v241, v242
    v_max3_f32 v125, v125, v243, v252
    v_max3_f32 v125, v125, v253, v254
    v_max3_f32 v125, v125, v255, v88
    v_max3_f32 v125, v125, v89, v90
    v_max_f32 v125, v125, v91
    v_max3_f32 v126, v232, v233, v234
    v_max3_f32 v126, v126, v235, v244
    v_max3_f32 v126, v126, v245, v246
    v_max3_f32 v126, v126, v247, v80
    v_max3_f32 v126, v126, v81, v82
    v_max3_f32 v126, v126, v83, v12
    v_max3_f32 v126, v126, v13, v14
    v_max_f32 v126, v126, v15
    v_mov_b32 v127, v124
    v_mov_b32 v114, v125
    v_mov_b32 v115, v126
    v_permlane32_swap_b32 v124, v127
    v_permlane32_swap_b32 v125, v114
    v_permlane32_swap_b32 v126, v115
    v_max_f32 v124, v124, v127
    v_max_f32 v125, v125, v114
    v_max_f32 v126, v126, v115
    v_mov_b32 v127, v124
    v_mov_b32 v114, v125
    v_mov_b32 v115, v126
    v_permlane16_swap_b32 v124, v127
    v_permlane16_swap_b32 v125, v114
    v_permlane16_swap_b32 v126, v115
    v_max_f32 v124, v124, v127
    v_max_f32 v125, v125, v114
    v_max_f32 v126, v126, v115
    v_sub_f32 v127, v124, v108
    v_sub_f32 v114, v125, v109
    v_sub_f32 v115, v126, v110
    v_max3_f32 v127, v127, v114, v115
    v_cmp_lt_f32 vcc, s62, v127
    s_nop 3
    s_cbranch_vccz L_17
    v_max_f32 v124, v124, v108
    v_sub_f32 v111, v108, v124
    v_mul_f32 v111, s13, v111
    v_exp_f32 v111, v111
    v_mov_b32 v108, v124
    v_max_f32 v125, v125, v109
    v_sub_f32 v112, v109, v125
    v_mul_f32 v112, s13, v112
    v_exp_f32 v112, v112
    v_mov_b32 v109, v125
    v_max_f32 v126, v126, v110
    v_sub_f32 v113, v110, v126
    v_mul_f32 v113, s13, v113
    v_exp_f32 v113, v113
    v_mov_b32 v110, v126
    v_mul_f32 v128, v128, v111
    v_mul_f32 v129, v129, v111
    v_mul_f32 v130, v130, v111
    v_mul_f32 v131, v131, v111
    v_mul_f32 v132, v132, v112
    v_mul_f32 v133, v133, v112
    v_mul_f32 v134, v134, v112
    v_mul_f32 v135, v135, v112
    v_mul_f32 v136, v136, v113
    v_mul_f32 v137, v137, v113
    v_mul_f32 v138, v138, v113
    v_mul_f32 v139, v139, v113
    v_mul_f32 v140, v140, v111
    v_mul_f32 v141, v141, v111
    v_mul_f32 v142, v142, v111
    v_mul_f32 v143, v143, v111
    v_mul_f32 v144, v144, v112
    v_mul_f32 v145, v145, v112
    v_mul_f32 v146, v146, v112
    v_mul_f32 v147, v147, v112
    v_mul_f32 v148, v148, v113
    v_mul_f32 v149, v149, v113
    v_mul_f32 v150, v150, v113
    v_mul_f32 v151, v151, v113
    v_mul_f32 v152, v152, v111
    v_mul_f32 v153, v153, v111
    v_mul_f32 v154, v154, v111
    v_mul_f32 v155, v155, v111
    v_mul_f32 v156, v156, v112
    v_mul_f32 v157, v157, v112
    v_mul_f32 v158, v158, v112
    v_mul_f32 v159, v159, v112
    v_mul_f32 v160, v160, v113
    v_mul_f32 v161, v161, v113
    v_mul_f32 v162, v162, v113
    v_mul_f32 v163, v163, v113
    v_mul_f32 v164, v164, v111
    v_mul_f32 v165, v165, v111
    v_mul_f32 v166, v166, v111
    v_mul_f32 v167, v167, v111
    v_mul_f32 v168, v168, v112
    v_mul_f32 v169, v169, v112
    v_mul_f32 v170, v170, v112
    v_mul_f32 v171, v171, v112
    v_mul_f32 v172, v172, v113
    v_mul_f32 v173, v173, v113
    v_mul_f32 v174, v174, v113
    v_mul_f32 v175, v175, v113
    v_mul_f32 v176, v176, v111
    v_mul_f32 v177, v177, v111
    v_mul_f32 v178, v178, v111
    v_mul_f32 v179, v179, v111
    v_mul_f32 v180, v180, v112
    v_mul_f32 v181, v181, v112
    v_mul_f32 v182, v182, v112
    v_mul_f32 v183, v183, v112
    v_mul_f32 v184, v184, v113
    v_mul_f32 v185, v185, v113
    v_mul_f32 v186, v186, v113
    v_mul_f32 v187, v187, v113
    v_mul_f32 v188, v188, v111
    v_mul_f32 v189, v189, v111
    v_mul_f32 v190, v190, v111
    v_mul_f32 v191, v191, v111
    v_mul_f32 v192, v192, v112
    v_mul_f32 v193, v193, v112
    v_mul_f32 v194, v194, v112
    v_mul_f32 v195, v195, v112
    v_mul_f32 v196, v196, v113
    v_mul_f32 v197, v197, v113
    v_mul_f32 v198, v198, v113
    v_mul_f32 v199, v199, v113
    v_mul_f32 v200, v200, v111
    v_mul_f32 v201, v201, v111
    v_mul_f32 v202, v202, v111
    v_mul_f32 v203, v203, v111
    v_mul_f32 v204, v204, v112
    v_mul_f32 v205, v205, v112
    v_mul_f32 v206, v206, v112
    v_mul_f32 v207, v207, v112
    v_mul_f32 v208, v208, v113
    v_mul_f32 v209, v209, v113
    v_mul_f32 v210, v210, v113
    v_mul_f32 v211, v211, v113
    v_mul_f32 v212, v212, v111
    v_mul_f32 v213, v213, v111
    v_mul_f32 v214, v214, v111
    v_mul_f32 v215, v215, v111
    v_mul_f32 v216, v216, v112
    v_mul_f32 v217, v217, v112
    v_mul_f32 v218, v218, v112
    v_mul_f32 v219, v219, v112
    v_mul_f32 v220, v220, v113
    v_mul_f32 v221, v221, v113
    v_mul_f32 v222, v222, v113
    v_mul_f32 v223, v223, v113
    v_mul_f32 v2, v2, v111
    v_mul_f32 v3, v3, v111
    v_mul_f32 v4, v4, v111
    v_mul_f32 v5, v5, v111
    v_mul_f32 v8, v8, v112
    v_mul_f32 v9, v9, v112
    v_mul_f32 v10, v10, v112
    v_mul_f32 v11, v11, v112
    v_mul_f32 v120, v120, v113
    v_mul_f32 v121, v121, v113
    v_mul_f32 v122, v122, v113
    v_mul_f32 v123, v123, v113
L_17:
    s_nop 1
    v_mul_f32 v124, s13, v108
    v_mul_f32 v125, s13, v109
    v_mul_f32 v126, s13, v110
    v_fma_f32 v224, v224, s13, -v124
    v_fma_f32 v225, v225, s13, -v124
    v_fma_f32 v226, v226, s13, -v124
    v_fma_f32 v227, v227, s13, -v124
    v_fma_f32 v236, v236, s13, -v124
    v_fma_f32 v237, v237, s13, -v124
    v_fma_f32 v238, v238, s13, -v124
    v_fma_f32 v239, v239, s13, -v124
    v_fma_f32 v248, v248, s13, -v124
    v_fma_f32 v249, v249, s13, -v124
    v_fma_f32 v250, v250, s13, -v124
    v_fma_f32 v251, v251, s13, -v124
    v_fma_f32 v84, v84, s13, -v124
    v_fma_f32 v85, v85, s13, -v124
    v_fma_f32 v86, v86, s13, -v124
    v_fma_f32 v87, v87, s13, -v124
    v_exp_f32 v224, v224
    v_exp_f32 v225, v225
    v_exp_f32 v226, v226
    v_exp_f32 v227, v227
    v_exp_f32 v236, v236
    v_exp_f32 v237, v237
    v_exp_f32 v238, v238
    v_exp_f32 v239, v239
    v_exp_f32 v248, v248
    v_exp_f32 v249, v249
    v_exp_f32 v250, v250
    v_exp_f32 v251, v251
    v_exp_f32 v84, v84
    v_exp_f32 v85, v85
    v_exp_f32 v86, v86
    v_exp_f32 v87, v87
    v_cvt_pk_bf16_f32 v224, v224, v225
    v_cvt_pk_bf16_f32 v225, v226, v227
    v_cvt_pk_bf16_f32 v226, v236, v237
    v_cvt_pk_bf16_f32 v227, v238, v239
    v_cvt_pk_bf16_f32 v248, v248, v249
    v_cvt_pk_bf16_f32 v249, v250, v251
    v_cvt_pk_bf16_f32 v250, v84, v85
    v_cvt_pk_bf16_f32 v251, v86, v87
    v_fma_f32 v228, v228, s13, -v125
    v_fma_f32 v229, v229, s13, -v125
    v_fma_f32 v230, v230, s13, -v125
    v_fma_f32 v231, v231, s13, -v125
    v_fma_f32 v240, v240, s13, -v125
    v_fma_f32 v241, v241, s13, -v125
    v_fma_f32 v242, v242, s13, -v125
    v_fma_f32 v243, v243, s13, -v125
    v_fma_f32 v252, v252, s13, -v125
    v_fma_f32 v253, v253, s13, -v125
    v_fma_f32 v254, v254, s13, -v125
    v_fma_f32 v255, v255, s13, -v125
    v_fma_f32 v88, v88, s13, -v125
    v_fma_f32 v89, v89, s13, -v125
    v_fma_f32 v90, v90, s13, -v125
    v_fma_f32 v91, v91, s13, -v125
    v_exp_f32 v228, v228
    v_exp_f32 v229, v229
    v_exp_f32 v230, v230
    v_exp_f32 v231, v231
    v_exp_f32 v240, v240
    v_exp_f32 v241, v241
    v_exp_f32 v242, v242
    v_exp_f32 v243, v243
    v_exp_f32 v252, v252
    v_exp_f32 v253, v253
    v_exp_f32 v254, v254
    v_exp_f32 v255, v255
    v_exp_f32 v88, v88
    v_exp_f32 v89, v89
    v_exp_f32 v90, v90
    v_exp_f32 v91, v91
    v_cvt_pk_bf16_f32 v228, v228, v229
    v_cvt_pk_bf16_f32 v229, v230, v231
    v_cvt_pk_bf16_f32 v230, v240, v241
    v_cvt_pk_bf16_f32 v231, v242, v243
    v_cvt_pk_bf16_f32 v252, v252, v253
    v_cvt_pk_bf16_f32 v253, v254, v255
    v_cvt_pk_bf16_f32 v254, v88, v89
    v_cvt_pk_bf16_f32 v255, v90, v91
    v_fma_f32 v232, v232, s13, -v126
    v_fma_f32 v233, v233, s13, -v126
    v_fma_f32 v234, v234, s13, -v126
    v_fma_f32 v235, v235, s13, -v126
    v_fma_f32 v244, v244, s13, -v126
    v_fma_f32 v245, v245, s13, -v126
    v_fma_f32 v246, v246, s13, -v126
    v_fma_f32 v247, v247, s13, -v126
    v_fma_f32 v80, v80, s13, -v126
    v_fma_f32 v81, v81, s13, -v126
    v_fma_f32 v82, v82, s13, -v126
    v_fma_f32 v83, v83, s13, -v126
    v_fma_f32 v12, v12, s13, -v126
    v_fma_f32 v13, v13, s13, -v126
    v_fma_f32 v14, v14, s13, -v126
    v_fma_f32 v15, v15, s13, -v126
    v_exp_f32 v232, v232
    v_exp_f32 v233, v233
    v_exp_f32 v234, v234
    v_exp_f32 v235, v235
    v_exp_f32 v244, v244
    v_exp_f32 v245, v245
    v_exp_f32 v246, v246
    v_exp_f32 v247, v247
    v_exp_f32 v80, v80
    v_exp_f32 v81, v81
    v_exp_f32 v82, v82
    v_exp_f32 v83, v83
    v_exp_f32 v12, v12
    v_exp_f32 v13, v13
    v_exp_f32 v14, v14
    v_exp_f32 v15, v15
    v_cvt_pk_bf16_f32 v232, v232, v233
    v_cvt_pk_bf16_f32 v233, v234, v235
    v_cvt_pk_bf16_f32 v234, v244, v245
    v_cvt_pk_bf16_f32 v235, v246, v247
    v_cvt_pk_bf16_f32 v80, v80, v81
    v_cvt_pk_bf16_f32 v81, v82, v83
    v_cvt_pk_bf16_f32 v82, v12, v13
    v_cvt_pk_bf16_f32 v83, v14, v15
    ds_read_b64_tr_b16 v[76:77], v103
    ds_read_b64_tr_b16 v[78:79], v103 offset:4096
    s_waitcnt lgkmcnt(6)
    v_mfma_f32_16x16x32_bf16 v[128:131], v[64:67], v[224:227], v[128:131]
    v_mfma_f32_16x16x32_bf16 v[132:135], v[64:67], v[228:231], v[132:135]
    v_mfma_f32_16x16x32_bf16 v[136:139], v[64:67], v[232:235], v[136:139]
    v_mfma_f32_16x16x32_bf16 v[2:5], v[116:119], v[224:227], v[2:5]
    v_mfma_f32_16x16x32_bf16 v[8:11], v[116:119], v[228:231], v[8:11]
    v_mfma_f32_16x16x32_bf16 v[120:123], v[116:119], v[232:235], v[120:123]
    ds_read_b64_tr_b16 v[64:65], v104
    ds_read_b64_tr_b16 v[66:67], v104 offset:4096
    s_waitcnt lgkmcnt(6)
    v_mfma_f32_16x16x32_bf16 v[140:143], v[68:71], v[224:227], v[140:143]
    v_mfma_f32_16x16x32_bf16 v[144:147], v[68:71], v[228:231], v[144:147]
    v_mfma_f32_16x16x32_bf16 v[148:151], v[68:71], v[232:235], v[148:151]
    ds_read_b64_tr_b16 v[68:69], v105
    ds_read_b64_tr_b16 v[70:71], v105 offset:4096
    s_waitcnt lgkmcnt(6)
    v_mfma_f32_16x16x32_bf16 v[152:155], v[72:75], v[224:227], v[152:155]
    v_mfma_f32_16x16x32_bf16 v[156:159], v[72:75], v[228:231], v[156:159]
    v_mfma_f32_16x16x32_bf16 v[160:163], v[72:75], v[232:235], v[160:163]
    ds_read_b64_tr_b16 v[72:73], v106
    ds_read_b64_tr_b16 v[74:75], v106 offset:4096
    s_waitcnt lgkmcnt(6)
    v_mfma_f32_16x16x32_bf16 v[164:167], v[76:79], v[224:227], v[164:167]
    v_mfma_f32_16x16x32_bf16 v[168:171], v[76:79], v[228:231], v[168:171]
    v_mfma_f32_16x16x32_bf16 v[172:175], v[76:79], v[232:235], v[172:175]
    ds_read_b64_tr_b16 v[76:77], v107
    ds_read_b64_tr_b16 v[78:79], v107 offset:4096
    s_waitcnt lgkmcnt(6)
    v_mfma_f32_16x16x32_bf16 v[176:179], v[64:67], v[224:227], v[176:179]
    v_mfma_f32_16x16x32_bf16 v[180:183], v[64:67], v[228:231], v[180:183]
    v_mfma_f32_16x16x32_bf16 v[184:187], v[64:67], v[232:235], v[184:187]
    ds_read_b64_tr_b16 v[64:65], v100 offset:8192
    ds_read_b64_tr_b16 v[66:67], v100 offset:12288
    s_waitcnt lgkmcnt(6)
    v_mfma_f32_16x16x32_bf16 v[188:191], v[68:71], v[224:227], v[188:191]
    v_mfma_f32_16x16x32_bf16 v[192:195], v[68:71], v[228:231], v[192:195]
    v_mfma_f32_16x16x32_bf16 v[196:199], v[68:71], v[232:235], v[196:199]
    ds_read_b64_tr_b16 v[68:69], v101 offset:8192
    ds_read_b64_tr_b16 v[70:71], v101 offset:12288
    s_waitcnt lgkmcnt(6)
    v_mfma_f32_16x16x32_bf16 v[200:203], v[72:75], v[224:227], v[200:203]
    v_mfma_f32_16x16x32_bf16 v[204:207], v[72:75], v[228:231], v[204:207]
    v_mfma_f32_16x16x32_bf16 v[208:211], v[72:75], v[232:235], v[208:211]
    ds_read_b64_tr_b16 v[72:73], v102 offset:8192
    ds_read_b64_tr_b16 v[74:75], v102 offset:12288
    s_waitcnt lgkmcnt(6)
    v_mfma_f32_16x16x32_bf16 v[212:215], v[76:79], v[224:227], v[212:215]
    v_mfma_f32_16x16x32_bf16 v[216:219], v[76:79], v[228:231], v[216:219]
    v_mfma_f32_16x16x32_bf16 v[220:223], v[76:79], v[232:235], v[220:223]
    ds_read_b64_tr_b16 v[76:77], v103 offset:8192
    ds_read_b64_tr_b16 v[78:79], v103 offset:12288
    s_waitcnt lgkmcnt(6)
    v_mfma_f32_16x16x32_bf16 v[128:131], v[64:67], v[248:251], v[128:131]
    v_mfma_f32_16x16x32_bf16 v[132:135], v[64:67], v[252:255], v[132:135]
    v_mfma_f32_16x16x32_bf16 v[136:139], v[64:67], v[80:83], v[136:139]
    v_mfma_f32_16x16x32_bf16 v[2:5], v[116:119], v[248:251], v[2:5]
    v_mfma_f32_16x16x32_bf16 v[8:11], v[116:119], v[252:255], v[8:11]
    v_mfma_f32_16x16x32_bf16 v[120:123], v[116:119], v[80:83], v[120:123]
    ds_read_b64_tr_b16 v[64:65], v104 offset:8192
    ds_read_b64_tr_b16 v[66:67], v104 offset:12288
    s_waitcnt lgkmcnt(6)
    v_mfma_f32_16x16x32_bf16 v[140:143], v[68:71], v[248:251], v[140:143]
    v_mfma_f32_16x16x32_bf16 v[144:147], v[68:71], v[252:255], v[144:147]
    v_mfma_f32_16x16x32_bf16 v[148:151], v[68:71], v[80:83], v[148:151]
    ds_read_b64_tr_b16 v[68:69], v105 offset:8192
    ds_read_b64_tr_b16 v[70:71], v105 offset:12288
    s_waitcnt lgkmcnt(6)
    v_mfma_f32_16x16x32_bf16 v[152:155], v[72:75], v[248:251], v[152:155]
    v_mfma_f32_16x16x32_bf16 v[156:159], v[72:75], v[252:255], v[156:159]
    v_mfma_f32_16x16x32_bf16 v[160:163], v[72:75], v[80:83], v[160:163]
    ds_read_b64_tr_b16 v[72:73], v106 offset:8192
    ds_read_b64_tr_b16 v[74:75], v106 offset:12288
    s_waitcnt lgkmcnt(6)
    v_mfma_f32_16x16x32_bf16 v[164:167], v[76:79], v[248:251], v[164:167]
    v_mfma_f32_16x16x32_bf16 v[168:171], v[76:79], v[252:255], v[168:171]
    v_mfma_f32_16x16x32_bf16 v[172:175], v[76:79], v[80:83], v[172:175]
    ds_read_b64_tr_b16 v[76:77], v107 offset:8192
    ds_read_b64_tr_b16 v[78:79], v107 offset:12288
    s_waitcnt lgkmcnt(6)
    v_mfma_f32_16x16x32_bf16 v[176:179], v[64:67], v[248:251], v[176:179]
    v_mfma_f32_16x16x32_bf16 v[180:183], v[64:67], v[252:255], v[180:183]
    v_mfma_f32_16x16x32_bf16 v[184:187], v[64:67], v[80:83], v[184:187]
    s_waitcnt lgkmcnt(4)
    v_mfma_f32_16x16x32_bf16 v[188:191], v[68:71], v[248:251], v[188:191]
    v_mfma_f32_16x16x32_bf16 v[192:195], v[68:71], v[252:255], v[192:195]
    v_mfma_f32_16x16x32_bf16 v[196:199], v[68:71], v[80:83], v[196:199]
    s_waitcnt lgkmcnt(2)
    v_mfma_f32_16x16x32_bf16 v[200:203], v[72:75], v[248:251], v[200:203]
    v_mfma_f32_16x16x32_bf16 v[204:207], v[72:75], v[252:255], v[204:207]
    v_mfma_f32_16x16x32_bf16 v[208:211], v[72:75], v[80:83], v[208:211]
    s_waitcnt lgkmcnt(0)
    v_mfma_f32_16x16x32_bf16 v[212:215], v[76:79], v[248:251], v[212:215]
    v_mfma_f32_16x16x32_bf16 v[216:219], v[76:79], v[252:255], v[216:219]
    v_mfma_f32_16x16x32_bf16 v[220:223], v[76:79], v[80:83], v[220:223]
    v_xor_b32 v96, 65536, v96
    v_xor_b32 v97, 65536, v97
    v_xor_b32 v98, 65536, v98
    v_xor_b32 v99, 65536, v99
    v_xor_b32 v100, 65536, v100
    v_xor_b32 v101, 65536, v101
    v_xor_b32 v102, 65536, v102
    v_xor_b32 v103, 65536, v103
    v_xor_b32 v104, 65536, v104
    v_xor_b32 v105, 65536, v105
    v_xor_b32 v106, 65536, v106
    v_xor_b32 v107, 65536, v107
    s_waitcnt vmcnt(0)
    s_barrier
    ds_read_b128 v[64:67], v96
    ds_read_b128 v[68:71], v97
    ds_read_b128 v[72:75], v98
    ds_read_b128 v[76:79], v99
    s_waitcnt lgkmcnt(3)
    v_mfma_f32_16x16x32_bf16 v[224:227], v[64:67], v[16:19], 0
    v_mfma_f32_16x16x32_bf16 v[228:231], v[64:67], v[32:35], 0
    v_mfma_f32_16x16x32_bf16 v[232:235], v[64:67], v[48:51], 0
    ds_read_b128 v[64:67], v96 offset:4096
    s_waitcnt lgkmcnt(3)
    v_mfma_f32_16x16x32_bf16 v[224:227], v[68:71], v[20:23], v[224:227]
    v_mfma_f32_16x16x32_bf16 v[228:231], v[68:71], v[36:39], v[228:231]
    v_mfma_f32_16x16x32_bf16 v[232:235], v[68:71], v[52:55], v[232:235]
    ds_read_b128 v[68:71], v97 offset:4096
    s_waitcnt lgkmcnt(3)
    v_mfma_f32_16x16x32_bf16 v[224:227], v[72:75], v[24:27], v[224:227]
    v_mfma_f32_16x16x32_bf16 v[228:231], v[72:75], v[40:43], v[228:231]
    v_mfma_f32_16x16x32_bf16 v[232:235], v[72:75], v[56:59], v[232:235]
    ds_read_b128 v[72:75], v98 offset:4096
    s_waitcnt lgkmcnt(3)
    v_mfma_f32_16x16x32_bf16 v[224:227], v[76:79], v[28:31], v[224:227]
    v_mfma_f32_16x16x32_bf16 v[228:231], v[76:79], v[44:47], v[228:231]
    v_mfma_f32_16x16x32_bf16 v[232:235], v[76:79], v[60:63], v[232:235]
    ds_read_b128 v[76:79], v99 offset:4096
    s_waitcnt lgkmcnt(3)
    v_mfma_f32_16x16x32_bf16 v[236:239], v[64:67], v[16:19], 0
    v_mfma_f32_16x16x32_bf16 v[240:243], v[64:67], v[32:35], 0
    v_mfma_f32_16x16x32_bf16 v[244:247], v[64:67], v[48:51], 0
    ds_read_b128 v[64:67], v96 offset:8192
    s_waitcnt lgkmcnt(3)
    v_mfma_f32_16x16x32_bf16 v[236:239], v[68:71], v[20:23], v[236:239]
    v_mfma_f32_16x16x32_bf16 v[240:243], v[68:71], v[36:39], v[240:243]
    v_mfma_f32_16x16x32_bf16 v[244:247], v[68:71], v[52:55], v[244:247]
    ds_read_b128 v[68:71], v97 offset:8192
    s_waitcnt lgkmcnt(3)
    v_mfma_f32_16x16x32_bf16 v[236:239], v[72:75], v[24:27], v[236:239]
    v_mfma_f32_16x16x32_bf16 v[240:243], v[72:75], v[40:43], v[240:243]
    v_mfma_f32_16x16x32_bf16 v[244:247], v[72:75], v[56:59], v[244:247]
    ds_read_b128 v[72:75], v98 offset:8192
    s_waitcnt lgkmcnt(3)
    v_mfma_f32_16x16x32_bf16 v[236:239], v[76:79], v[28:31], v[236:239]
    v_mfma_f32_16x16x32_bf16 v[240:243], v[76:79], v[44:47], v[240:243]
    v_mfma_f32_16x16x32_bf16 v[244:247], v[76:79], v[60:63], v[244:247]
    ds_read_b128 v[76:79], v99 offset:8192
    s_waitcnt lgkmcnt(3)
    v_mfma_f32_16x16x32_bf16 v[248:251], v[64:67], v[16:19], 0
    v_mfma_f32_16x16x32_bf16 v[252:255], v[64:67], v[32:35], 0
    v_mfma_f32_16x16x32_bf16 v[80:83], v[64:67], v[48:51], 0
    ds_read_b128 v[64:67], v96 offset:12288
    s_waitcnt lgkmcnt(3)
    v_mfma_f32_16x16x32_bf16 v[248:251], v[68:71], v[20:23], v[248:251]
    v_mfma_f32_16x16x32_bf16 v[252:255], v[68:71], v[36:39], v[252:255]
    v_mfma_f32_16x16x32_bf16 v[80:83], v[68:71], v[52:55], v[80:83]
    ds_read_b128 v[68:71], v97 offset:12288
    s_waitcnt lgkmcnt(3)
    v_mfma_f32_16x16x32_bf16 v[248:251], v[72:75], v[24:27], v[248:251]
    v_mfma_f32_16x16x32_bf16 v[252:255], v[72:75], v[40:43], v[252:255]
    v_mfma_f32_16x16x32_bf16 v[80:83], v[72:75], v[56:59], v[80:83]
    ds_read_b128 v[72:75], v98 offset:12288
    s_waitcnt lgkmcnt(3)
    v_mfma_f32_16x16x32_bf16 v[248:251], v[76:79], v[28:31], v[248:251]
    v_mfma_f32_16x16x32_bf16 v[252:255], v[76:79], v[44:47], v[252:255]
    v_mfma_f32_16x16x32_bf16 v[80:83], v[76:79], v[60:63], v[80:83]
    ds_read_b128 v[76:79], v99 offset:12288
    s_waitcnt lgkmcnt(3)
    v_mfma_f32_16x16x32_bf16 v[84:87], v[64:67], v[16:19], 0
    v_mfma_f32_16x16x32_bf16 v[88:91], v[64:67], v[32:35], 0
    v_mfma_f32_16x16x32_bf16 v[12:15], v[64:67], v[48:51], 0
    s_waitcnt lgkmcnt(2)
    v_mfma_f32_16x16x32_bf16 v[84:87], v[68:71], v[20:23], v[84:87]
    v_mfma_f32_16x16x32_bf16 v[88:91], v[68:71], v[36:39], v[88:91]
    v_mfma_f32_16x16x32_bf16 v[12:15], v[68:71], v[52:55], v[12:15]
    s_waitcnt lgkmcnt(1)
    v_mfma_f32_16x16x32_bf16 v[84:87], v[72:75], v[24:27], v[84:87]
    v_mfma_f32_16x16x32_bf16 v[88:91], v[72:75], v[40:43], v[88:91]
    v_mfma_f32_16x16x32_bf16 v[12:15], v[72:75], v[56:59], v[12:15]
    s_waitcnt lgkmcnt(0)
    v_mfma_f32_16x16x32_bf16 v[84:87], v[76:79], v[28:31], v[84:87]
    v_mfma_f32_16x16x32_bf16 v[88:91], v[76:79], v[44:47], v[88:91]
    v_mfma_f32_16x16x32_bf16 v[12:15], v[76:79], v[60:63], v[12:15]
    s_lshl_b32 s14, s4, 19
    s_lshl_b32 s61, s5, 15
    s_add_u32 s14, s14, s61
    s_lshl_b32 s61, s3, 12
    s_add_u32 s61, s61, s14
    s_add_u32 s14, s61, 0
    buffer_load_dwordx4 v[16:19], v6, s[48:51], s14 offen
    s_add_u32 s14, s61, 1024
    buffer_load_dwordx4 v[16:19], v6, s[48:51], s14 offen
    s_add_u32 s14, s61, 2048
    buffer_load_dwordx4 v[16:19], v6, s[48:51], s14 offen
    s_add_u32 s14, s61, 3072
    buffer_load_dwordx4 v[16:19], v6, s[48:51], s14 offen
    ds_read_b64_tr_b16 v[64:65], v100
    ds_read_b64_tr_b16 v[66:67], v100 offset:4096
    ds_read_b64_tr_b16 v[68:69], v101
    ds_read_b64_tr_b16 v[70:71], v101 offset:4096
    ds_read_b64_tr_b16 v[72:73], v102
    ds_read_b64_tr_b16 v[74:75], v102 offset:4096
    v_max3_f32 v124, v224, v225, v226
    v_max3_f32 v124, v124, v227, v236
    v_max3_f32 v124, v124, v237, v238
    v_max3_f32 v124, v124, v239, v248
    v_max3_f32 v124, v124, v249, v250
    v_max3_f32 v124, v124, v251, v84
    v_max3_f32 v124, v124, v85, v86
    v_max_f32 v124, v124, v87
    v_max3_f32 v125, v228, v229, v230
    v_max3_f32 v125, v125, v231, v240
    v_max3_f32 v125, v125, v241, v242
    v_max3_f32 v125, v125, v243, v252
    v_max3_f32 v125, v125, v253, v254
    v_max3_f32 v125, v125, v255, v88
    v_max3_f32 v125, v125, v89, v90
    v_max_f32 v125, v125, v91
    v_max3_f32 v126, v232, v233, v234
    v_max3_f32 v126, v126, v235, v244
    v_max3_f32 v126, v126, v245, v246
    v_max3_f32 v126, v126, v247, v80
    v_max3_f32 v126, v126, v81, v82
    v_max3_f32 v126, v126, v83, v12
    v_max3_f32 v126, v126, v13, v14
    v_max_f32 v126, v126, v15
    v_mov_b32 v127, v124
    v_mov_b32 v114, v125
    v_mov_b32 v115, v126
    v_permlane32_swap_b32 v124, v127
    v_permlane32_swap_b32 v125, v114
    v_permlane32_swap_b32 v126, v115
    v_max_f32 v124, v124, v127
    v_max_f32 v125, v125, v114
    v_max_f32 v126, v126, v115
    v_mov_b32 v127, v124
    v_mov_b32 v114, v125
    v_mov_b32 v115, v126
    v_permlane16_swap_b32 v124, v127
    v_permlane16_swap_b32 v125, v114
    v_permlane16_swap_b32 v126, v115
    v_max_f32 v124, v124, v127
    v_max_f32 v125, v125, v114
    v_max_f32 v126, v126, v115
    v_sub_f32 v127, v124, v108
    v_sub_f32 v114, v125, v109
    v_sub_f32 v115, v126, v110
    v_max3_f32 v127, v127, v114, v115
    v_cmp_lt_f32 vcc, s62, v127
    s_nop 3
    s_cbranch_vccz L_18
    v_max_f32 v124, v124, v108
    v_sub_f32 v111, v108, v124
    v_mul_f32 v111, s13, v111
    v_exp_f32 v111, v111
    v_mov_b32 v108, v124
    v_max_f32 v125, v125, v109
    v_sub_f32 v112, v109, v125
    v_mul_f32 v112, s13, v112
    v_exp_f32 v112, v112
    v_mov_b32 v109, v125
    v_max_f32 v126, v126, v110
    v_sub_f32 v113, v110, v126
    v_mul_f32 v113, s13, v113
    v_exp_f32 v113, v113
    v_mov_b32 v110, v126
    v_mul_f32 v128, v128, v111
    v_mul_f32 v129, v129, v111
    v_mul_f32 v130, v130, v111
    v_mul_f32 v131, v131, v111
    v_mul_f32 v132, v132, v112
    v_mul_f32 v133, v133, v112
    v_mul_f32 v134, v134, v112
    v_mul_f32 v135, v135, v112
    v_mul_f32 v136, v136, v113
    v_mul_f32 v137, v137, v113
    v_mul_f32 v138, v138, v113
    v_mul_f32 v139, v139, v113
    v_mul_f32 v140, v140, v111
    v_mul_f32 v141, v141, v111
    v_mul_f32 v142, v142, v111
    v_mul_f32 v143, v143, v111
    v_mul_f32 v144, v144, v112
    v_mul_f32 v145, v145, v112
    v_mul_f32 v146, v146, v112
    v_mul_f32 v147, v147, v112
    v_mul_f32 v148, v148, v113
    v_mul_f32 v149, v149, v113
    v_mul_f32 v150, v150, v113
    v_mul_f32 v151, v151, v113
    v_mul_f32 v152, v152, v111
    v_mul_f32 v153, v153, v111
    v_mul_f32 v154, v154, v111
    v_mul_f32 v155, v155, v111
    v_mul_f32 v156, v156, v112
    v_mul_f32 v157, v157, v112
    v_mul_f32 v158, v158, v112
    v_mul_f32 v159, v159, v112
    v_mul_f32 v160, v160, v113
    v_mul_f32 v161, v161, v113
    v_mul_f32 v162, v162, v113
    v_mul_f32 v163, v163, v113
    v_mul_f32 v164, v164, v111
    v_mul_f32 v165, v165, v111
    v_mul_f32 v166, v166, v111
    v_mul_f32 v167, v167, v111
    v_mul_f32 v168, v168, v112
    v_mul_f32 v169, v169, v112
    v_mul_f32 v170, v170, v112
    v_mul_f32 v171, v171, v112
    v_mul_f32 v172, v172, v113
    v_mul_f32 v173, v173, v113
    v_mul_f32 v174, v174, v113
    v_mul_f32 v175, v175, v113
    v_mul_f32 v176, v176, v111
    v_mul_f32 v177, v177, v111
    v_mul_f32 v178, v178, v111
    v_mul_f32 v179, v179, v111
    v_mul_f32 v180, v180, v112
    v_mul_f32 v181, v181, v112
    v_mul_f32 v182, v182, v112
    v_mul_f32 v183, v183, v112
    v_mul_f32 v184, v184, v113
    v_mul_f32 v185, v185, v113
    v_mul_f32 v186, v186, v113
    v_mul_f32 v187, v187, v113
    v_mul_f32 v188, v188, v111
    v_mul_f32 v189, v189, v111
    v_mul_f32 v190, v190, v111
    v_mul_f32 v191, v191, v111
    v_mul_f32 v192, v192, v112
    v_mul_f32 v193, v193, v112
    v_mul_f32 v194, v194, v112
    v_mul_f32 v195, v195, v112
    v_mul_f32 v196, v196, v113
    v_mul_f32 v197, v197, v113
    v_mul_f32 v198, v198, v113
    v_mul_f32 v199, v199, v113
    v_mul_f32 v200, v200, v111
    v_mul_f32 v201, v201, v111
    v_mul_f32 v202, v202, v111
    v_mul_f32 v203, v203, v111
    v_mul_f32 v204, v204, v112
    v_mul_f32 v205, v205, v112
    v_mul_f32 v206, v206, v112
    v_mul_f32 v207, v207, v112
    v_mul_f32 v208, v208, v113
    v_mul_f32 v209, v209, v113
    v_mul_f32 v210, v210, v113
    v_mul_f32 v211, v211, v113
    v_mul_f32 v212, v212, v111
    v_mul_f32 v213, v213, v111
    v_mul_f32 v214, v214, v111
    v_mul_f32 v215, v215, v111
    v_mul_f32 v216, v216, v112
    v_mul_f32 v217, v217, v112
    v_mul_f32 v218, v218, v112
    v_mul_f32 v219, v219, v112
    v_mul_f32 v220, v220, v113
    v_mul_f32 v221, v221, v113
    v_mul_f32 v222, v222, v113
    v_mul_f32 v223, v223, v113
    v_mul_f32 v2, v2, v111
    v_mul_f32 v3, v3, v111
    v_mul_f32 v4, v4, v111
    v_mul_f32 v5, v5, v111
    v_mul_f32 v8, v8, v112
    v_mul_f32 v9, v9, v112
    v_mul_f32 v10, v10, v112
    v_mul_f32 v11, v11, v112
    v_mul_f32 v120, v120, v113
    v_mul_f32 v121, v121, v113
    v_mul_f32 v122, v122, v113
    v_mul_f32 v123, v123, v113
L_18:
    s_nop 1
    v_mul_f32 v124, s13, v108
    v_mul_f32 v125, s13, v109
    v_mul_f32 v126, s13, v110
    v_fma_f32 v224, v224, s13, -v124
    v_fma_f32 v225, v225, s13, -v124
    v_fma_f32 v226, v226, s13, -v124
    v_fma_f32 v227, v227, s13, -v124
    v_fma_f32 v236, v236, s13, -v124
    v_fma_f32 v237, v237, s13, -v124
    v_fma_f32 v238, v238, s13, -v124
    v_fma_f32 v239, v239, s13, -v124
    v_fma_f32 v248, v248, s13, -v124
    v_fma_f32 v249, v249, s13, -v124
    v_fma_f32 v250, v250, s13, -v124
    v_fma_f32 v251, v251, s13, -v124
    v_fma_f32 v84, v84, s13, -v124
    v_fma_f32 v85, v85, s13, -v124
    v_fma_f32 v86, v86, s13, -v124
    v_fma_f32 v87, v87, s13, -v124
    v_exp_f32 v224, v224
    v_exp_f32 v225, v225
    v_exp_f32 v226, v226
    v_exp_f32 v227, v227
    v_exp_f32 v236, v236
    v_exp_f32 v237, v237
    v_exp_f32 v238, v238
    v_exp_f32 v239, v239
    v_exp_f32 v248, v248
    v_exp_f32 v249, v249
    v_exp_f32 v250, v250
    v_exp_f32 v251, v251
    v_exp_f32 v84, v84
    v_exp_f32 v85, v85
    v_exp_f32 v86, v86
    v_exp_f32 v87, v87
    v_cvt_pk_bf16_f32 v224, v224, v225
    v_cvt_pk_bf16_f32 v225, v226, v227
    v_cvt_pk_bf16_f32 v226, v236, v237
    v_cvt_pk_bf16_f32 v227, v238, v239
    v_cvt_pk_bf16_f32 v248, v248, v249
    v_cvt_pk_bf16_f32 v249, v250, v251
    v_cvt_pk_bf16_f32 v250, v84, v85
    v_cvt_pk_bf16_f32 v251, v86, v87
    v_fma_f32 v228, v228, s13, -v125
    v_fma_f32 v229, v229, s13, -v125
    v_fma_f32 v230, v230, s13, -v125
    v_fma_f32 v231, v231, s13, -v125
    v_fma_f32 v240, v240, s13, -v125
    v_fma_f32 v241, v241, s13, -v125
    v_fma_f32 v242, v242, s13, -v125
    v_fma_f32 v243, v243, s13, -v125
    v_fma_f32 v252, v252, s13, -v125
    v_fma_f32 v253, v253, s13, -v125
    v_fma_f32 v254, v254, s13, -v125
    v_fma_f32 v255, v255, s13, -v125
    v_fma_f32 v88, v88, s13, -v125
    v_fma_f32 v89, v89, s13, -v125
    v_fma_f32 v90, v90, s13, -v125
    v_fma_f32 v91, v91, s13, -v125
    v_exp_f32 v228, v228
    v_exp_f32 v229, v229
    v_exp_f32 v230, v230
    v_exp_f32 v231, v231
    v_exp_f32 v240, v240
    v_exp_f32 v241, v241
    v_exp_f32 v242, v242
    v_exp_f32 v243, v243
    v_exp_f32 v252, v252
    v_exp_f32 v253, v253
    v_exp_f32 v254, v254
    v_exp_f32 v255, v255
    v_exp_f32 v88, v88
    v_exp_f32 v89, v89
    v_exp_f32 v90, v90
    v_exp_f32 v91, v91
    v_cvt_pk_bf16_f32 v228, v228, v229
    v_cvt_pk_bf16_f32 v229, v230, v231
    v_cvt_pk_bf16_f32 v230, v240, v241
    v_cvt_pk_bf16_f32 v231, v242, v243
    v_cvt_pk_bf16_f32 v252, v252, v253
    v_cvt_pk_bf16_f32 v253, v254, v255
    v_cvt_pk_bf16_f32 v254, v88, v89
    v_cvt_pk_bf16_f32 v255, v90, v91
    v_fma_f32 v232, v232, s13, -v126
    v_fma_f32 v233, v233, s13, -v126
    v_fma_f32 v234, v234, s13, -v126
    v_fma_f32 v235, v235, s13, -v126
    v_fma_f32 v244, v244, s13, -v126
    v_fma_f32 v245, v245, s13, -v126
    v_fma_f32 v246, v246, s13, -v126
    v_fma_f32 v247, v247, s13, -v126
    v_fma_f32 v80, v80, s13, -v126
    v_fma_f32 v81, v81, s13, -v126
    v_fma_f32 v82, v82, s13, -v126
    v_fma_f32 v83, v83, s13, -v126
    v_fma_f32 v12, v12, s13, -v126
    v_fma_f32 v13, v13, s13, -v126
    v_fma_f32 v14, v14, s13, -v126
    v_fma_f32 v15, v15, s13, -v126
    v_exp_f32 v232, v232
    v_exp_f32 v233, v233
    v_exp_f32 v234, v234
    v_exp_f32 v235, v235
    v_exp_f32 v244, v244
    v_exp_f32 v245, v245
    v_exp_f32 v246, v246
    v_exp_f32 v247, v247
    v_exp_f32 v80, v80
    v_exp_f32 v81, v81
    v_exp_f32 v82, v82
    v_exp_f32 v83, v83
    v_exp_f32 v12, v12
    v_exp_f32 v13, v13
    v_exp_f32 v14, v14
    v_exp_f32 v15, v15
    v_cvt_pk_bf16_f32 v232, v232, v233
    v_cvt_pk_bf16_f32 v233, v234, v235
    v_cvt_pk_bf16_f32 v234, v244, v245
    v_cvt_pk_bf16_f32 v235, v246, v247
    v_cvt_pk_bf16_f32 v80, v80, v81
    v_cvt_pk_bf16_f32 v81, v82, v83
    v_cvt_pk_bf16_f32 v82, v12, v13
    v_cvt_pk_bf16_f32 v83, v14, v15
    ds_read_b64_tr_b16 v[76:77], v103
    ds_read_b64_tr_b16 v[78:79], v103 offset:4096
    s_waitcnt lgkmcnt(6)
    v_mfma_f32_16x16x32_bf16 v[128:131], v[64:67], v[224:227], v[128:131]
    v_mfma_f32_16x16x32_bf16 v[132:135], v[64:67], v[228:231], v[132:135]
    v_mfma_f32_16x16x32_bf16 v[136:139], v[64:67], v[232:235], v[136:139]
    v_mfma_f32_16x16x32_bf16 v[2:5], v[116:119], v[224:227], v[2:5]
    v_mfma_f32_16x16x32_bf16 v[8:11], v[116:119], v[228:231], v[8:11]
    v_mfma_f32_16x16x32_bf16 v[120:123], v[116:119], v[232:235], v[120:123]
    ds_read_b64_tr_b16 v[64:65], v104
    ds_read_b64_tr_b16 v[66:67], v104 offset:4096
    s_waitcnt lgkmcnt(6)
    v_mfma_f32_16x16x32_bf16 v[140:143], v[68:71], v[224:227], v[140:143]
    v_mfma_f32_16x16x32_bf16 v[144:147], v[68:71], v[228:231], v[144:147]
    v_mfma_f32_16x16x32_bf16 v[148:151], v[68:71], v[232:235], v[148:151]
    ds_read_b64_tr_b16 v[68:69], v105
    ds_read_b64_tr_b16 v[70:71], v105 offset:4096
    s_waitcnt lgkmcnt(6)
    v_mfma_f32_16x16x32_bf16 v[152:155], v[72:75], v[224:227], v[152:155]
    v_mfma_f32_16x16x32_bf16 v[156:159], v[72:75], v[228:231], v[156:159]
    v_mfma_f32_16x16x32_bf16 v[160:163], v[72:75], v[232:235], v[160:163]
    ds_read_b64_tr_b16 v[72:73], v106
    ds_read_b64_tr_b16 v[74:75], v106 offset:4096
    s_waitcnt lgkmcnt(6)
    v_mfma_f32_16x16x32_bf16 v[164:167], v[76:79], v[224:227], v[164:167]
    v_mfma_f32_16x16x32_bf16 v[168:171], v[76:79], v[228:231], v[168:171]
    v_mfma_f32_16x16x32_bf16 v[172:175], v[76:79], v[232:235], v[172:175]
    ds_read_b64_tr_b16 v[76:77], v107
    ds_read_b64_tr_b16 v[78:79], v107 offset:4096
    s_waitcnt lgkmcnt(6)
    v_mfma_f32_16x16x32_bf16 v[176:179], v[64:67], v[224:227], v[176:179]
    v_mfma_f32_16x16x32_bf16 v[180:183], v[64:67], v[228:231], v[180:183]
    v_mfma_f32_16x16x32_bf16 v[184:187], v[64:67], v[232:235], v[184:187]
    ds_read_b64_tr_b16 v[64:65], v100 offset:8192
    ds_read_b64_tr_b16 v[66:67], v100 offset:12288
    s_waitcnt lgkmcnt(6)
    v_mfma_f32_16x16x32_bf16 v[188:191], v[68:71], v[224:227], v[188:191]
    v_mfma_f32_16x16x32_bf16 v[192:195], v[68:71], v[228:231], v[192:195]
    v_mfma_f32_16x16x32_bf16 v[196:199], v[68:71], v[232:235], v[196:199]
    ds_read_b64_tr_b16 v[68:69], v101 offset:8192
    ds_read_b64_tr_b16 v[70:71], v101 offset:12288
    s_waitcnt lgkmcnt(6)
    v_mfma_f32_16x16x32_bf16 v[200:203], v[72:75], v[224:227], v[200:203]
    v_mfma_f32_16x16x32_bf16 v[204:207], v[72:75], v[228:231], v[204:207]
    v_mfma_f32_16x16x32_bf16 v[208:211], v[72:75], v[232:235], v[208:211]
    ds_read_b64_tr_b16 v[72:73], v102 offset:8192
    ds_read_b64_tr_b16 v[74:75], v102 offset:12288
    s_waitcnt lgkmcnt(6)
    v_mfma_f32_16x16x32_bf16 v[212:215], v[76:79], v[224:227], v[212:215]
    v_mfma_f32_16x16x32_bf16 v[216:219], v[76:79], v[228:231], v[216:219]
    v_mfma_f32_16x16x32_bf16 v[220:223], v[76:79], v[232:235], v[220:223]
    ds_read_b64_tr_b16 v[76:77], v103 offset:8192
    ds_read_b64_tr_b16 v[78:79], v103 offset:12288
    s_waitcnt lgkmcnt(6)
    v_mfma_f32_16x16x32_bf16 v[128:131], v[64:67], v[248:251], v[128:131]
    v_mfma_f32_16x16x32_bf16 v[132:135], v[64:67], v[252:255], v[132:135]
    v_mfma_f32_16x16x32_bf16 v[136:139], v[64:67], v[80:83], v[136:139]
    v_mfma_f32_16x16x32_bf16 v[2:5], v[116:119], v[248:251], v[2:5]
    v_mfma_f32_16x16x32_bf16 v[8:11], v[116:119], v[252:255], v[8:11]
    v_mfma_f32_16x16x32_bf16 v[120:123], v[116:119], v[80:83], v[120:123]
    ds_read_b64_tr_b16 v[64:65], v104 offset:8192
    ds_read_b64_tr_b16 v[66:67], v104 offset:12288
    s_waitcnt lgkmcnt(6)
    v_mfma_f32_16x16x32_bf16 v[140:143], v[68:71], v[248:251], v[140:143]
    v_mfma_f32_16x16x32_bf16 v[144:147], v[68:71], v[252:255], v[144:147]
    v_mfma_f32_16x16x32_bf16 v[148:151], v[68:71], v[80:83], v[148:151]
    ds_read_b64_tr_b16 v[68:69], v105 offset:8192
    ds_read_b64_tr_b16 v[70:71], v105 offset:12288
    s_waitcnt lgkmcnt(6)
    v_mfma_f32_16x16x32_bf16 v[152:155], v[72:75], v[248:251], v[152:155]
    v_mfma_f32_16x16x32_bf16 v[156:159], v[72:75], v[252:255], v[156:159]
    v_mfma_f32_16x16x32_bf16 v[160:163], v[72:75], v[80:83], v[160:163]
    ds_read_b64_tr_b16 v[72:73], v106 offset:8192
    ds_read_b64_tr_b16 v[74:75], v106 offset:12288
    s_waitcnt lgkmcnt(6)
    v_mfma_f32_16x16x32_bf16 v[164:167], v[76:79], v[248:251], v[164:167]
    v_mfma_f32_16x16x32_bf16 v[168:171], v[76:79], v[252:255], v[168:171]
    v_mfma_f32_16x16x32_bf16 v[172:175], v[76:79], v[80:83], v[172:175]
    ds_read_b64_tr_b16 v[76:77], v107 offset:8192
    ds_read_b64_tr_b16 v[78:79], v107 offset:12288
    s_waitcnt lgkmcnt(6)
    v_mfma_f32_16x16x32_bf16 v[176:179], v[64:67], v[248:251], v[176:179]
    v_mfma_f32_16x16x32_bf16 v[180:183], v[64:67], v[252:255], v[180:183]
    v_mfma_f32_16x16x32_bf16 v[184:187], v[64:67], v[80:83], v[184:187]
    s_waitcnt lgkmcnt(4)
    v_mfma_f32_16x16x32_bf16 v[188:191], v[68:71], v[248:251], v[188:191]
    v_mfma_f32_16x16x32_bf16 v[192:195], v[68:71], v[252:255], v[192:195]
    v_mfma_f32_16x16x32_bf16 v[196:199], v[68:71], v[80:83], v[196:199]
    s_waitcnt lgkmcnt(2)
    v_mfma_f32_16x16x32_bf16 v[200:203], v[72:75], v[248:251], v[200:203]
    v_mfma_f32_16x16x32_bf16 v[204:207], v[72:75], v[252:255], v[204:207]
    v_mfma_f32_16x16x32_bf16 v[208:211], v[72:75], v[80:83], v[208:211]
    s_waitcnt lgkmcnt(0)
    v_mfma_f32_16x16x32_bf16 v[212:215], v[76:79], v[248:251], v[212:215]
    v_mfma_f32_16x16x32_bf16 v[216:219], v[76:79], v[252:255], v[216:219]
    v_mfma_f32_16x16x32_bf16 v[220:223], v[76:79], v[80:83], v[220:223]
    v_xor_b32 v96, 65536, v96
    v_xor_b32 v97, 65536, v97
    v_xor_b32 v98, 65536, v98
    v_xor_b32 v99, 65536, v99
    v_xor_b32 v100, 65536, v100
    v_xor_b32 v101, 65536, v101
    v_xor_b32 v102, 65536, v102
    v_xor_b32 v103, 65536, v103
    v_xor_b32 v104, 65536, v104
    v_xor_b32 v105, 65536, v105
    v_xor_b32 v106, 65536, v106
    v_xor_b32 v107, 65536, v107
    s_setprio 0
    v_mov_b32 v64, v2
    v_mov_b32 v65, v8
    v_mov_b32 v66, v120
    v_and_b32 v1, 63, v0
    v_and_b32 v2, 15, v1
    v_lshrrev_b32 v3, 4, v1
    v_lshrrev_b32 v4, 2, v1
    v_and_b32 v4, 3, v4
    v_and_b32 v5, 3, v1
    v_lshlrev_b32 v7, 3, v3
    v_add_u32 v7, v7, v4
    v_mul_u32_u24 v7, 1056, v7
    v_lshlrev_b32 v8, 7, v3
    v_add_u32 v7, v7, v8
    v_lshlrev_b32 v8, 3, v5
    v_add_u32 v7, v7, v8
    s_lshl_b32 s9, s3, 7
    s_add_u32 s9, s9, 50688
    v_add_u32 v8, s9, v7
    v_add_u32 v9, 34304, v8
    v_add_u32 v10, 68608, v8
    v_mul_u32_u24 v11, 1056, v2
    v_lshlrev_b32 v12, 4, v3
    v_add_u32 v11, v11, v12
    s_mul_i32 s14, s3, 384
    s_add_u32 s14, s14, 153600
    v_lshlrev_b32 v13, 3, v2
    v_add_u32 v13, s14, v13
    v_mov_b32 v68, v108
    v_mov_b32 v69, v64
    ds_write_b64 v13, v[68:69]
    v_mov_b32 v70, v109
    v_mov_b32 v71, v65
    ds_write_b64 v13, v[70:71] offset:128
    v_mov_b32 v72, v110
    v_mov_b32 v73, v66
    ds_write_b64 v13, v[72:73] offset:256
    s_xor_b32 s14, s3, 4
    s_mul_i32 s14, s14, 384
    s_add_u32 s14, s14, 153600
    v_lshlrev_b32 v12, 3, v2
    v_add_u32 v12, s14, v12
    s_mul_i32 s14, s3, 12288
    s_add_u32 s14, s14, 50688
    v_add_u32 v13, s14, v6
    s_xor_b32 s14, s3, 4
    s_mul_i32 s14, s14, 12288
    s_add_u32 s14, s14, 50688
    v_add_u32 v14, s14, v6
    v_mul_u32_u24 v15, 1056, v2
    v_lshlrev_b32 v7, 3, v3
    v_add_u32 v15, v15, v7
    s_and_b32 s14, s3, 3
    s_lshl_b32 s14, s14, 8
    s_add_u32 s14, s14, 0
    v_add_u32 v15, s14, v15
    s_barrier
    s_cmp_ge_u32 s3, 4
    s_cbranch_scc1 L_kh1
    ds_write_b128 v13, v[176:179]
    ds_write_b128 v13, v[180:183] offset:1024
    ds_write_b128 v13, v[184:187] offset:2048
    ds_write_b128 v13, v[188:191] offset:3072
    ds_write_b128 v13, v[192:195] offset:4096
    ds_write_b128 v13, v[196:199] offset:5120
    ds_write_b128 v13, v[200:203] offset:6144
    ds_write_b128 v13, v[204:207] offset:7168
    ds_write_b128 v13, v[208:211] offset:8192
    ds_write_b128 v13, v[212:215] offset:9216
    ds_write_b128 v13, v[216:219] offset:10240
    ds_write_b128 v13, v[220:223] offset:11264
    s_waitcnt lgkmcnt(0)
    s_barrier
    ds_read_b64 v[74:75], v12
    ds_read_b64 v[76:77], v12 offset:128
    ds_read_b64 v[78:79], v12 offset:256
    ds_read_b128 v[20:23], v14
    ds_read_b128 v[24:27], v14 offset:1024
    ds_read_b128 v[28:31], v14 offset:2048
    ds_read_b128 v[32:35], v14 offset:3072
    ds_read_b128 v[36:39], v14 offset:4096
    ds_read_b128 v[40:43], v14 offset:5120
    ds_read_b128 v[44:47], v14 offset:6144
    ds_read_b128 v[48:51], v14 offset:7168
    ds_read_b128 v[52:55], v14 offset:8192
    ds_read_b128 v[56:59], v14 offset:9216
    ds_read_b128 v[60:63], v14 offset:10240
    ds_read_b128 v[92:95], v14 offset:11264
    s_waitcnt lgkmcnt(12)
    v_max_f32 v127, v74, v108
    v_sub_f32 v111, v108, v127
    v_mul_f32 v111, s13, v111
    v_exp_f32 v111, v111
    v_sub_f32 v124, v74, v127
    v_mul_f32 v124, s13, v124
    v_exp_f32 v124, v124
    v_mul_f32 v127, v64, v111
    v_fma_f32 v127, v75, v124, v127
    v_rcp_f32 v127, v127
    s_nop 0
    v_mul_f32 v111, v111, v127
    v_mul_f32 v124, v124, v127
    v_max_f32 v127, v76, v109
    v_sub_f32 v112, v109, v127
    v_mul_f32 v112, s13, v112
    v_exp_f32 v112, v112
    v_sub_f32 v125, v76, v127
    v_mul_f32 v125, s13, v125
    v_exp_f32 v125, v125
    v_mul_f32 v127, v65, v112
    v_fma_f32 v127, v77, v125, v127
    v_rcp_f32 v127, v127
    s_nop 0
    v_mul_f32 v112, v112, v127
    v_mul_f32 v125, v125, v127
    v_max_f32 v127, v78, v110
    v_sub_f32 v113, v110, v127
    v_mul_f32 v113, s13, v113
    v_exp_f32 v113, v113
    v_sub_f32 v126, v78, v127
    v_mul_f32 v126, s13, v126
    v_exp_f32 v126, v126
    v_mul_f32 v127, v66, v113
    v_fma_f32 v127, v79, v126, v127
    v_rcp_f32 v127, v127
    s_nop 0
    v_mul_f32 v113, v113, v127
    v_mul_f32 v126, v126, v127
    s_waitcnt lgkmcnt(0)
    v_mul_f32 v128, v128, v111
    v_fma_f32 v128, v20, v124, v128
    v_mul_f32 v129, v129, v111
    v_fma_f32 v129, v21, v124, v129
    v_mul_f32 v130, v130, v111
    v_fma_f32 v130, v22, v124, v130
    v_mul_f32 v131, v131, v111
    v_fma_f32 v131, v23, v124, v131
    v_cvt_pk_bf16_f32 v128, v128, v129
    v_cvt_pk_bf16_f32 v129, v130, v131
    ds_write_b64 v15, v[128:129]
    v_mul_f32 v132, v132, v112
    v_fma_f32 v132, v24, v125, v132
    v_mul_f32 v133, v133, v112
    v_fma_f32 v133, v25, v125, v133
    v_mul_f32 v134, v134, v112
    v_fma_f32 v134, v26, v125, v134
    v_mul_f32 v135, v135, v112
    v_fma_f32 v135, v27, v125, v135
    v_cvt_pk_bf16_f32 v132, v132, v133
    v_cvt_pk_bf16_f32 v133, v134, v135
    ds_write_b64 v15, v[132:133] offset:16896
    v_mul_f32 v136, v136, v113
    v_fma_f32 v136, v28, v126, v136
    v_mul_f32 v137, v137, v113
    v_fma_f32 v137, v29, v126, v137
    v_mul_f32 v138, v138, v113
    v_fma_f32 v138, v30, v126, v138
    v_mul_f32 v139, v139, v113
    v_fma_f32 v139, v31, v126, v139
    v_cvt_pk_bf16_f32 v136, v136, v137
    v_cvt_pk_bf16_f32 v137, v138, v139
    ds_write_b64 v15, v[136:137] offset:33792
    v_mul_f32 v140, v140, v111
    v_fma_f32 v140, v32, v124, v140
    v_mul_f32 v141, v141, v111
    v_fma_f32 v141, v33, v124, v141
    v_mul_f32 v142, v142, v111
    v_fma_f32 v142, v34, v124, v142
    v_mul_f32 v143, v143, v111
    v_fma_f32 v143, v35, v124, v143
    v_cvt_pk_bf16_f32 v140, v140, v141
    v_cvt_pk_bf16_f32 v141, v142, v143
    ds_write_b64 v15, v[140:141] offset:32
    v_mul_f32 v144, v144, v112
    v_fma_f32 v144, v36, v125, v144
    v_mul_f32 v145, v145, v112
    v_fma_f32 v145, v37, v125, v145
    v_mul_f32 v146, v146, v112
    v_fma_f32 v146, v38, v125, v146
    v_mul_f32 v147, v147, v112
    v_fma_f32 v147, v39, v125, v147
    v_cvt_pk_bf16_f32 v144, v144, v145
    v_cvt_pk_bf16_f32 v145, v146, v147
    ds_write_b64 v15, v[144:145] offset:16928
    v_mul_f32 v148, v148, v113
    v_fma_f32 v148, v40, v126, v148
    v_mul_f32 v149, v149, v113
    v_fma_f32 v149, v41, v126, v149
    v_mul_f32 v150, v150, v113
    v_fma_f32 v150, v42, v126, v150
    v_mul_f32 v151, v151, v113
    v_fma_f32 v151, v43, v126, v151
    v_cvt_pk_bf16_f32 v148, v148, v149
    v_cvt_pk_bf16_f32 v149, v150, v151
    ds_write_b64 v15, v[148:149] offset:33824
    v_mul_f32 v152, v152, v111
    v_fma_f32 v152, v44, v124, v152
    v_mul_f32 v153, v153, v111
    v_fma_f32 v153, v45, v124, v153
    v_mul_f32 v154, v154, v111
    v_fma_f32 v154, v46, v124, v154
    v_mul_f32 v155, v155, v111
    v_fma_f32 v155, v47, v124, v155
    v_cvt_pk_bf16_f32 v152, v152, v153
    v_cvt_pk_bf16_f32 v153, v154, v155
    ds_write_b64 v15, v[152:153] offset:64
    v_mul_f32 v156, v156, v112
    v_fma_f32 v156, v48, v125, v156
    v_mul_f32 v157, v157, v112
    v_fma_f32 v157, v49, v125, v157
    v_mul_f32 v158, v158, v112
    v_fma_f32 v158, v50, v125, v158
    v_mul_f32 v159, v159, v112
    v_fma_f32 v159, v51, v125, v159
    v_cvt_pk_bf16_f32 v156, v156, v157
    v_cvt_pk_bf16_f32 v157, v158, v159
    ds_write_b64 v15, v[156:157] offset:16960
    v_mul_f32 v160, v160, v113
    v_fma_f32 v160, v52, v126, v160
    v_mul_f32 v161, v161, v113
    v_fma_f32 v161, v53, v126, v161
    v_mul_f32 v162, v162, v113
    v_fma_f32 v162, v54, v126, v162
    v_mul_f32 v163, v163, v113
    v_fma_f32 v163, v55, v126, v163
    v_cvt_pk_bf16_f32 v160, v160, v161
    v_cvt_pk_bf16_f32 v161, v162, v163
    ds_write_b64 v15, v[160:161] offset:33856
    v_mul_f32 v164, v164, v111
    v_fma_f32 v164, v56, v124, v164
    v_mul_f32 v165, v165, v111
    v_fma_f32 v165, v57, v124, v165
    v_mul_f32 v166, v166, v111
    v_fma_f32 v166, v58, v124, v166
    v_mul_f32 v167, v167, v111
    v_fma_f32 v167, v59, v124, v167
    v_cvt_pk_bf16_f32 v164, v164, v165
    v_cvt_pk_bf16_f32 v165, v166, v167
    ds_write_b64 v15, v[164:165] offset:96
    v_mul_f32 v168, v168, v112
    v_fma_f32 v168, v60, v125, v168
    v_mul_f32 v169, v169, v112
    v_fma_f32 v169, v61, v125, v169
    v_mul_f32 v170, v170, v112
    v_fma_f32 v170, v62, v125, v170
    v_mul_f32 v171, v171, v112
    v_fma_f32 v171, v63, v125, v171
    v_cvt_pk_bf16_f32 v168, v168, v169
    v_cvt_pk_bf16_f32 v169, v170, v171
    ds_write_b64 v15, v[168:169] offset:16992
    v_mul_f32 v172, v172, v113
    v_fma_f32 v172, v92, v126, v172
    v_mul_f32 v173, v173, v113
    v_fma_f32 v173, v93, v126, v173
    v_mul_f32 v174, v174, v113
    v_fma_f32 v174, v94, v126, v174
    v_mul_f32 v175, v175, v113
    v_fma_f32 v175, v95, v126, v175
    v_cvt_pk_bf16_f32 v172, v172, v173
    v_cvt_pk_bf16_f32 v173, v174, v175
    ds_write_b64 v15, v[172:173] offset:33888
    s_branch L_khdone
L_kh1:
    s_nop 3
    ds_write_b128 v13, v[128:131]
    ds_write_b128 v13, v[132:135] offset:1024
    ds_write_b128 v13, v[136:139] offset:2048
    ds_write_b128 v13, v[140:143] offset:3072
    ds_write_b128 v13, v[144:147] offset:4096
    ds_write_b128 v13, v[148:151] offset:5120
    ds_write_b128 v13, v[152:155] offset:6144
    ds_write_b128 v13, v[156:159] offset:7168
    ds_write_b128 v13, v[160:163] offset:8192
    ds_write_b128 v13, v[164:167] offset:9216
    ds_write_b128 v13, v[168:171] offset:10240
    ds_write_b128 v13, v[172:175] offset:11264
    s_waitcnt lgkmcnt(0)
    s_barrier
    ds_read_b64 v[74:75], v12
    ds_read_b64 v[76:77], v12 offset:128
    ds_read_b64 v[78:79], v12 offset:256
    ds_read_b128 v[20:23], v14
    ds_read_b128 v[24:27], v14 offset:1024
    ds_read_b128 v[28:31], v14 offset:2048
    ds_read_b128 v[32:35], v14 offset:3072
    ds_read_b128 v[36:39], v14 offset:4096
    ds_read_b128 v[40:43], v14 offset:5120
    ds_read_b128 v[44:47], v14 offset:6144
    ds_read_b128 v[48:51], v14 offset:7168
    ds_read_b128 v[52:55], v14 offset:8192
    ds_read_b128 v[56:59], v14 offset:9216
    ds_read_b128 v[60:63], v14 offset:10240
    ds_read_b128 v[92:95], v14 offset:11264
    s_waitcnt lgkmcnt(12)
    v_max_f32 v127, v74, v108
    v_sub_f32 v111, v108, v127
    v_mul_f32 v111, s13, v111
    v_exp_f32 v111, v111
    v_sub_f32 v124, v74, v127
    v_mul_f32 v124, s13, v124
    v_exp_f32 v124, v124
    v_mul_f32 v127, v64, v111
    v_fma_f32 v127, v75, v124, v127
    v_rcp_f32 v127, v127
    s_nop 0
    v_mul_f32 v111, v111, v127
    v_mul_f32 v124, v124, v127
    v_max_f32 v127, v76, v109
    v_sub_f32 v112, v109, v127
    v_mul_f32 v112, s13, v112
    v_exp_f32 v112, v112
    v_sub_f32 v125, v76, v127
    v_mul_f32 v125, s13, v125
    v_exp_f32 v125, v125
    v_mul_f32 v127, v65, v112
    v_fma_f32 v127, v77, v125, v127
    v_rcp_f32 v127, v127
    s_nop 0
    v_mul_f32 v112, v112, v127
    v_mul_f32 v125, v125, v127
    v_max_f32 v127, v78, v110
    v_sub_f32 v113, v110, v127
    v_mul_f32 v113, s13, v113
    v_exp_f32 v113, v113
    v_sub_f32 v126, v78, v127
    v_mul_f32 v126, s13, v126
    v_exp_f32 v126, v126
    v_mul_f32 v127, v66, v113
    v_fma_f32 v127, v79, v126, v127
    v_rcp_f32 v127, v127
    s_nop 0
    v_mul_f32 v113, v113, v127
    v_mul_f32 v126, v126, v127
    s_waitcnt lgkmcnt(0)
    v_mul_f32 v176, v176, v111
    v_fma_f32 v176, v20, v124, v176
    v_mul_f32 v177, v177, v111
    v_fma_f32 v177, v21, v124, v177
    v_mul_f32 v178, v178, v111
    v_fma_f32 v178, v22, v124, v178
    v_mul_f32 v179, v179, v111
    v_fma_f32 v179, v23, v124, v179
    v_cvt_pk_bf16_f32 v176, v176, v177
    v_cvt_pk_bf16_f32 v177, v178, v179
    ds_write_b64 v15, v[176:177] offset:128
    v_mul_f32 v180, v180, v112
    v_fma_f32 v180, v24, v125, v180
    v_mul_f32 v181, v181, v112
    v_fma_f32 v181, v25, v125, v181
    v_mul_f32 v182, v182, v112
    v_fma_f32 v182, v26, v125, v182
    v_mul_f32 v183, v183, v112
    v_fma_f32 v183, v27, v125, v183
    v_cvt_pk_bf16_f32 v180, v180, v181
    v_cvt_pk_bf16_f32 v181, v182, v183
    ds_write_b64 v15, v[180:181] offset:17024
    v_mul_f32 v184, v184, v113
    v_fma_f32 v184, v28, v126, v184
    v_mul_f32 v185, v185, v113
    v_fma_f32 v185, v29, v126, v185
    v_mul_f32 v186, v186, v113
    v_fma_f32 v186, v30, v126, v186
    v_mul_f32 v187, v187, v113
    v_fma_f32 v187, v31, v126, v187
    v_cvt_pk_bf16_f32 v184, v184, v185
    v_cvt_pk_bf16_f32 v185, v186, v187
    ds_write_b64 v15, v[184:185] offset:33920
    v_mul_f32 v188, v188, v111
    v_fma_f32 v188, v32, v124, v188
    v_mul_f32 v189, v189, v111
    v_fma_f32 v189, v33, v124, v189
    v_mul_f32 v190, v190, v111
    v_fma_f32 v190, v34, v124, v190
    v_mul_f32 v191, v191, v111
    v_fma_f32 v191, v35, v124, v191
    v_cvt_pk_bf16_f32 v188, v188, v189
    v_cvt_pk_bf16_f32 v189, v190, v191
    ds_write_b64 v15, v[188:189] offset:160
    v_mul_f32 v192, v192, v112
    v_fma_f32 v192, v36, v125, v192
    v_mul_f32 v193, v193, v112
    v_fma_f32 v193, v37, v125, v193
    v_mul_f32 v194, v194, v112
    v_fma_f32 v194, v38, v125, v194
    v_mul_f32 v195, v195, v112
    v_fma_f32 v195, v39, v125, v195
    v_cvt_pk_bf16_f32 v192, v192, v193
    v_cvt_pk_bf16_f32 v193, v194, v195
    ds_write_b64 v15, v[192:193] offset:17056
    v_mul_f32 v196, v196, v113
    v_fma_f32 v196, v40, v126, v196
    v_mul_f32 v197, v197, v113
    v_fma_f32 v197, v41, v126, v197
    v_mul_f32 v198, v198, v113
    v_fma_f32 v198, v42, v126, v198
    v_mul_f32 v199, v199, v113
    v_fma_f32 v199, v43, v126, v199
    v_cvt_pk_bf16_f32 v196, v196, v197
    v_cvt_pk_bf16_f32 v197, v198, v199
    ds_write_b64 v15, v[196:197] offset:33952
    v_mul_f32 v200, v200, v111
    v_fma_f32 v200, v44, v124, v200
    v_mul_f32 v201, v201, v111
    v_fma_f32 v201, v45, v124, v201
    v_mul_f32 v202, v202, v111
    v_fma_f32 v202, v46, v124, v202
    v_mul_f32 v203, v203, v111
    v_fma_f32 v203, v47, v124, v203
    v_cvt_pk_bf16_f32 v200, v200, v201
    v_cvt_pk_bf16_f32 v201, v202, v203
    ds_write_b64 v15, v[200:201] offset:192
    v_mul_f32 v204, v204, v112
    v_fma_f32 v204, v48, v125, v204
    v_mul_f32 v205, v205, v112
    v_fma_f32 v205, v49, v125, v205
    v_mul_f32 v206, v206, v112
    v_fma_f32 v206, v50, v125, v206
    v_mul_f32 v207, v207, v112
    v_fma_f32 v207, v51, v125, v207
    v_cvt_pk_bf16_f32 v204, v204, v205
    v_cvt_pk_bf16_f32 v205, v206, v207
    ds_write_b64 v15, v[204:205] offset:17088
    v_mul_f32 v208, v208, v113
    v_fma_f32 v208, v52, v126, v208
    v_mul_f32 v209, v209, v113
    v_fma_f32 v209, v53, v126, v209
    v_mul_f32 v210, v210, v113
    v_fma_f32 v210, v54, v126, v210
    v_mul_f32 v211, v211, v113
    v_fma_f32 v211, v55, v126, v211
    v_cvt_pk_bf16_f32 v208, v208, v209
    v_cvt_pk_bf16_f32 v209, v210, v211
    ds_write_b64 v15, v[208:209] offset:33984
    v_mul_f32 v212, v212, v111
    v_fma_f32 v212, v56, v124, v212
    v_mul_f32 v213, v213, v111
    v_fma_f32 v213, v57, v124, v213
    v_mul_f32 v214, v214, v111
    v_fma_f32 v214, v58, v124, v214
    v_mul_f32 v215, v215, v111
    v_fma_f32 v215, v59, v124, v215
    v_cvt_pk_bf16_f32 v212, v212, v213
    v_cvt_pk_bf16_f32 v213, v214, v215
    ds_write_b64 v15, v[212:213] offset:224
    v_mul_f32 v216, v216, v112
    v_fma_f32 v216, v60, v125, v216
    v_mul_f32 v217, v217, v112
    v_fma_f32 v217, v61, v125, v217
    v_mul_f32 v218, v218, v112
    v_fma_f32 v218, v62, v125, v218
    v_mul_f32 v219, v219, v112
    v_fma_f32 v219, v63, v125, v219
    v_cvt_pk_bf16_f32 v216, v216, v217
    v_cvt_pk_bf16_f32 v217, v218, v219
    ds_write_b64 v15, v[216:217] offset:17120
    v_mul_f32 v220, v220, v113
    v_fma_f32 v220, v92, v126, v220
    v_mul_f32 v221, v221, v113
    v_fma_f32 v221, v93, v126, v221
    v_mul_f32 v222, v222, v113
    v_fma_f32 v222, v94, v126, v222
    v_mul_f32 v223, v223, v113
    v_fma_f32 v223, v95, v126, v223
    v_cvt_pk_bf16_f32 v220, v220, v221
    v_cvt_pk_bf16_f32 v221, v222, v223
    ds_write_b64 v15, v[220:221] offset:34016
L_khdone:
    s_waitcnt vmcnt(0) lgkmcnt(0)
    s_barrier
    s_mul_i32 s62, s3, 4224
    s_lshr_b32 s13, s3, 1
    s_lshl_b32 s13, s13, 7
    s_add_u32 s62, s62, s13
    s_add_u32 s62, s62, 50688
    s_lshl_b32 s63, s4, 19
    s_lshl_b32 s13, s3, 12
    s_add_u32 s63, s63, s13
    s_add_u32 s60, s5, 0
    s_and_b32 s60, s60, 15
    s_mul_i32 s60, s60, 32768
    s_add_u32 s60, s60, s63
    s_add_u32 m0, s62, 0
    s_add_u32 s14, s60, 0
    buffer_load_dwordx4 v6, s[48:51], s14 offen lds
    s_add_u32 m0, s62, 1056
    s_add_u32 s14, s60, 1024
    buffer_load_dwordx4 v6, s[48:51], s14 offen lds
    s_add_u32 m0, s62, 2112
    s_add_u32 s14, s60, 2048
    buffer_load_dwordx4 v6, s[48:51], s14 offen lds
    s_add_u32 m0, s62, 3168
    s_add_u32 s14, s60, 3072
    buffer_load_dwordx4 v6, s[48:51], s14 offen lds
    s_add_u32 s60, s5, 1
    s_and_b32 s60, s60, 15
    s_mul_i32 s60, s60, 32768
    s_add_u32 s60, s60, s63
    s_add_u32 m0, s62, 34304
    s_add_u32 s14, s60, 0
    buffer_load_dwordx4 v6, s[48:51], s14 offen lds
    s_add_u32 m0, s62, 35360
    s_add_u32 s14, s60, 1024
    buffer_load_dwordx4 v6, s[48:51], s14 offen lds
    s_add_u32 m0, s62, 36416
    s_add_u32 s14, s60, 2048
    buffer_load_dwordx4 v6, s[48:51], s14 offen lds
    s_add_u32 m0, s62, 37472
    s_add_u32 s14, s60, 3072
    buffer_load_dwordx4 v6, s[48:51], s14 offen lds
    s_waitcnt vmcnt(4)
    s_barrier
    s_add_u32 s61, s5, 0
    s_and_b32 s61, s61, 15
    s_lshl_b32 s61, s61, 6
    v_add_u32 v7, s61, v11
    ds_read_b128 v[80:83], v7
    ds_read_b128 v[84:87], v7 offset:16896
    ds_read_b128 v[88:91], v7 offset:33792
    ds_read_b64_tr_b16 v[64:65], v8
    ds_read_b64_tr_b16 v[66:67], v8 offset:4224
    ds_read_b64_tr_b16 v[68:69], v8 offset:32
    ds_read_b64_tr_b16 v[70:71], v8 offset:4256
    ds_read_b64_tr_b16 v[72:73], v8 offset:64
    ds_read_b64_tr_b16 v[74:75], v8 offset:4288
    ds_read_b64_tr_b16 v[76:77], v8 offset:96
    ds_read_b64_tr_b16 v[78:79], v8 offset:4320
    s_add_u32 s60, s5, 2
    s_and_b32 s60, s60, 15
    s_mul_i32 s60, s60, 32768
    s_add_u32 s60, s60, s63
    s_add_u32 m0, s62, 68608
    s_add_u32 s14, s60, 0
    buffer_load_dwordx4 v6, s[48:51], s14 offen lds
    s_waitcnt lgkmcnt(6)
    v_mfma_f32_16x16x32_bf16 v[16:19], v[64:67], v[80:83], 0
    v_mfma_f32_16x16x32_bf16 v[20:23], v[64:67], v[84:87], 0
    v_mfma_f32_16x16x32_bf16 v[24:27], v[64:67], v[88:91], 0
    s_add_u32 m0, s62, 69664
    s_add_u32 s14, s60, 1024
    buffer_load_dwordx4 v6, s[48:51], s14 offen lds
    s_waitcnt lgkmcnt(4)
    v_mfma_f32_16x16x32_bf16 v[28:31], v[68:71], v[80:83], 0
    v_mfma_f32_16x16x32_bf16 v[32:35], v[68:71], v[84:87], 0
    v_mfma_f32_16x16x32_bf16 v[36:39], v[68:71], v[88:91], 0
    s_add_u32 m0, s62, 70720
    s_add_u32 s14, s60, 2048
    buffer_load_dwordx4 v6, s[48:51], s14 offen lds
    s_waitcnt lgkmcnt(2)
    v_mfma_f32_16x16x32_bf16 v[40:43], v[72:75], v[80:83], 0
    v_mfma_f32_16x16x32_bf16 v[44:47], v[72:75], v[84:87], 0
    v_mfma_f32_16x16x32_bf16 v[48:51], v[72:75], v[88:91], 0
    s_add_u32 m0, s62, 71776
    s_add_u32 s14, s60, 3072
    buffer_load_dwordx4 v6, s[48:51], s14 offen lds
    s_waitcnt lgkmcnt(0)
    v_mfma_f32_16x16x32_bf16 v[52:55], v[76:79], v[80:83], 0
    v_mfma_f32_16x16x32_bf16 v[56:59], v[76:79], v[84:87], 0
    v_mfma_f32_16x16x32_bf16 v[60:63], v[76:79], v[88:91], 0
    s_waitcnt vmcnt(4)
    s_barrier
    s_add_u32 s61, s5, 1
    s_and_b32 s61, s61, 15
    s_lshl_b32 s61, s61, 6
    v_add_u32 v7, s61, v11
    ds_read_b128 v[80:83], v7
    ds_read_b128 v[84:87], v7 offset:16896
    ds_read_b128 v[88:91], v7 offset:33792
    ds_read_b64_tr_b16 v[64:65], v9
    ds_read_b64_tr_b16 v[66:67], v9 offset:4224
    ds_read_b64_tr_b16 v[68:69], v9 offset:32
    ds_read_b64_tr_b16 v[70:71], v9 offset:4256
    ds_read_b64_tr_b16 v[72:73], v9 offset:64
    ds_read_b64_tr_b16 v[74:75], v9 offset:4288
    ds_read_b64_tr_b16 v[76:77], v9 offset:96
    ds_read_b64_tr_b16 v[78:79], v9 offset:4320
    s_add_u32 s60, s5, 3
    s_and_b32 s60, s60, 15
    s_mul_i32 s60, s60, 32768
    s_add_u32 s60, s60, s63
    s_add_u32 m0, s62, 0
    s_add_u32 s14, s60, 0
    buffer_load_dwordx4 v6, s[48:51], s14 offen lds
    s_waitcnt lgkmcnt(6)
    v_mfma_f32_16x16x32_bf16 v[16:19], v[64:67], v[80:83], v[16:19]
    v_mfma_f32_16x16x32_bf16 v[20:23], v[64:67], v[84:87], v[20:23]
    v_mfma_f32_16x16x32_bf16 v[24:27], v[64:67], v[88:91], v[24:27]
    s_add_u32 m0, s62, 1056
    s_add_u32 s14, s60, 1024
    buffer_load_dwordx4 v6, s[48:51], s14 offen lds
    s_waitcnt lgkmcnt(4)
    v_mfma_f32_16x16x32_bf16 v[28:31], v[68:71], v[80:83], v[28:31]
    v_mfma_f32_16x16x32_bf16 v[32:35], v[68:71], v[84:87], v[32:35]
    v_mfma_f32_16x16x32_bf16 v[36:39], v[68:71], v[88:91], v[36:39]
    s_add_u32 m0, s62, 2112
    s_add_u32 s14, s60, 2048
    buffer_load_dwordx4 v6, s[48:51], s14 offen lds
    s_waitcnt lgkmcnt(2)
    v_mfma_f32_16x16x32_bf16 v[40:43], v[72:75], v[80:83], v[40:43]
    v_mfma_f32_16x16x32_bf16 v[44:47], v[72:75], v[84:87], v[44:47]
    v_mfma_f32_16x16x32_bf16 v[48:51], v[72:75], v[88:91], v[48:51]
    s_add_u32 m0, s62, 3168
    s_add_u32 s14, s60, 3072
    buffer_load_dwordx4 v6, s[48:51], s14 offen lds
    s_waitcnt lgkmcnt(0)
    v_mfma_f32_16x16x32_bf16 v[52:55], v[76:79], v[80:83], v[52:55]
    v_mfma_f32_16x16x32_bf16 v[56:59], v[76:79], v[84:87], v[56:59]
    v_mfma_f32_16x16x32_bf16 v[60:63], v[76:79], v[88:91], v[60:63]
    s_waitcnt vmcnt(4)
    s_barrier
    s_add_u32 s61, s5, 2
    s_and_b32 s61, s61, 15
    s_lshl_b32 s61, s61, 6
    v_add_u32 v7, s61, v11
    ds_read_b128 v[80:83], v7
    ds_read_b128 v[84:87], v7 offset:16896
    ds_read_b128 v[88:91], v7 offset:33792
    ds_read_b64_tr_b16 v[64:65], v10
    ds_read_b64_tr_b16 v[66:67], v10 offset:4224
    ds_read_b64_tr_b16 v[68:69], v10 offset:32
    ds_read_b64_tr_b16 v[70:71], v10 offset:4256
    ds_read_b64_tr_b16 v[72:73], v10 offset:64
    ds_read_b64_tr_b16 v[74:75], v10 offset:4288
    ds_read_b64_tr_b16 v[76:77], v10 offset:96
    ds_read_b64_tr_b16 v[78:79], v10 offset:4320
    s_add_u32 s60, s5, 4
    s_and_b32 s60, s60, 15
    s_mul_i32 s60, s60, 32768
    s_add_u32 s60, s60, s63
    s_add_u32 m0, s62, 34304
    s_add_u32 s14, s60, 0
    buffer_load_dwordx4 v6, s[48:51], s14 offen lds
    s_waitcnt lgkmcnt(6)
    v_mfma_f32_16x16x32_bf16 v[16:19], v[64:67], v[80:83], v[16:19]
    v_mfma_f32_16x16x32_bf16 v[20:23], v[64:67], v[84:87], v[20:23]
    v_mfma_f32_16x16x32_bf16 v[24:27], v[64:67], v[88:91], v[24:27]
    s_add_u32 m0, s62, 35360
    s_add_u32 s14, s60, 1024
    buffer_load_dwordx4 v6, s[48:51], s14 offen lds
    s_waitcnt lgkmcnt(4)
    v_mfma_f32_16x16x32_bf16 v[28:31], v[68:71], v[80:83], v[28:31]
    v_mfma_f32_16x16x32_bf16 v[32:35], v[68:71], v[84:87], v[32:35]
    v_mfma_f32_16x16x32_bf16 v[36:39], v[68:71], v[88:91], v[36:39]
    s_add_u32 m0, s62, 36416
    s_add_u32 s14, s60, 2048
    buffer_load_dwordx4 v6, s[48:51], s14 offen lds
    s_waitcnt lgkmcnt(2)
    v_mfma_f32_16x16x32_bf16 v[40:43], v[72:75], v[80:83], v[40:43]
    v_mfma_f32_16x16x32_bf16 v[44:47], v[72:75], v[84:87], v[44:47]
    v_mfma_f32_16x16x32_bf16 v[48:51], v[72:75], v[88:91], v[48:51]
    s_add_u32 m0, s62, 37472
    s_add_u32 s14, s60, 3072
    buffer_load_dwordx4 v6, s[48:51], s14 offen lds
    s_waitcnt lgkmcnt(0)
    v_mfma_f32_16x16x32_bf16 v[52:55], v[76:79], v[80:83], v[52:55]
    v_mfma_f32_16x16x32_bf16 v[56:59], v[76:79], v[84:87], v[56:59]
    v_mfma_f32_16x16x32_bf16 v[60:63], v[76:79], v[88:91], v[60:63]
    s_waitcnt vmcnt(4)
    s_barrier
    s_add_u32 s61, s5, 3
    s_and_b32 s61, s61, 15
    s_lshl_b32 s61, s61, 6
    v_add_u32 v7, s61, v11
    ds_read_b128 v[80:83], v7
    ds_read_b128 v[84:87], v7 offset:16896
    ds_read_b128 v[88:91], v7 offset:33792
    ds_read_b64_tr_b16 v[64:65], v8
    ds_read_b64_tr_b16 v[66:67], v8 offset:4224
    ds_read_b64_tr_b16 v[68:69], v8 offset:32
    ds_read_b64_tr_b16 v[70:71], v8 offset:4256
    ds_read_b64_tr_b16 v[72:73], v8 offset:64
    ds_read_b64_tr_b16 v[74:75], v8 offset:4288
    ds_read_b64_tr_b16 v[76:77], v8 offset:96
    ds_read_b64_tr_b16 v[78:79], v8 offset:4320
    s_add_u32 s60, s5, 5
    s_and_b32 s60, s60, 15
    s_mul_i32 s60, s60, 32768
    s_add_u32 s60, s60, s63
    s_add_u32 m0, s62, 68608
    s_add_u32 s14, s60, 0
    buffer_load_dwordx4 v6, s[48:51], s14 offen lds
    s_waitcnt lgkmcnt(6)
    v_mfma_f32_16x16x32_bf16 v[16:19], v[64:67], v[80:83], v[16:19]
    v_mfma_f32_16x16x32_bf16 v[20:23], v[64:67], v[84:87], v[20:23]
    v_mfma_f32_16x16x32_bf16 v[24:27], v[64:67], v[88:91], v[24:27]
    s_add_u32 m0, s62, 69664
    s_add_u32 s14, s60, 1024
    buffer_load_dwordx4 v6, s[48:51], s14 offen lds
    s_waitcnt lgkmcnt(4)
    v_mfma_f32_16x16x32_bf16 v[28:31], v[68:71], v[80:83], v[28:31]
    v_mfma_f32_16x16x32_bf16 v[32:35], v[68:71], v[84:87], v[32:35]
    v_mfma_f32_16x16x32_bf16 v[36:39], v[68:71], v[88:91], v[36:39]
    s_add_u32 m0, s62, 70720
    s_add_u32 s14, s60, 2048
    buffer_load_dwordx4 v6, s[48:51], s14 offen lds
    s_waitcnt lgkmcnt(2)
    v_mfma_f32_16x16x32_bf16 v[40:43], v[72:75], v[80:83], v[40:43]
    v_mfma_f32_16x16x32_bf16 v[44:47], v[72:75], v[84:87], v[44:47]
    v_mfma_f32_16x16x32_bf16 v[48:51], v[72:75], v[88:91], v[48:51]
    s_add_u32 m0, s62, 71776
    s_add_u32 s14, s60, 3072
    buffer_load_dwordx4 v6, s[48:51], s14 offen lds
    s_waitcnt lgkmcnt(0)
    v_mfma_f32_16x16x32_bf16 v[52:55], v[76:79], v[80:83], v[52:55]
    v_mfma_f32_16x16x32_bf16 v[56:59], v[76:79], v[84:87], v[56:59]
    v_mfma_f32_16x16x32_bf16 v[60:63], v[76:79], v[88:91], v[60:63]
    s_waitcnt vmcnt(4)
    s_barrier
    s_add_u32 s61, s5, 4
    s_and_b32 s61, s61, 15
    s_lshl_b32 s61, s61, 6
    v_add_u32 v7, s61, v11
    ds_read_b128 v[80:83], v7
    ds_read_b128 v[84:87], v7 offset:16896
    ds_read_b128 v[88:91], v7 offset:33792
    ds_read_b64_tr_b16 v[64:65], v9
    ds_read_b64_tr_b16 v[66:67], v9 offset:4224
    ds_read_b64_tr_b16 v[68:69], v9 offset:32
    ds_read_b64_tr_b16 v[70:71], v9 offset:4256
    ds_read_b64_tr_b16 v[72:73], v9 offset:64
    ds_read_b64_tr_b16 v[74:75], v9 offset:4288
    ds_read_b64_tr_b16 v[76:77], v9 offset:96
    ds_read_b64_tr_b16 v[78:79], v9 offset:4320
    s_add_u32 s60, s5, 6
    s_and_b32 s60, s60, 15
    s_mul_i32 s60, s60, 32768
    s_add_u32 s60, s60, s63
    s_add_u32 m0, s62, 0
    s_add_u32 s14, s60, 0
    buffer_load_dwordx4 v6, s[48:51], s14 offen lds
    s_waitcnt lgkmcnt(6)
    v_mfma_f32_16x16x32_bf16 v[16:19], v[64:67], v[80:83], v[16:19]
    v_mfma_f32_16x16x32_bf16 v[20:23], v[64:67], v[84:87], v[20:23]
    v_mfma_f32_16x16x32_bf16 v[24:27], v[64:67], v[88:91], v[24:27]
    s_add_u32 m0, s62, 1056
    s_add_u32 s14, s60, 1024
    buffer_load_dwordx4 v6, s[48:51], s14 offen lds
    s_waitcnt lgkmcnt(4)
    v_mfma_f32_16x16x32_bf16 v[28:31], v[68:71], v[80:83], v[28:31]
    v_mfma_f32_16x16x32_bf16 v[32:35], v[68:71], v[84:87], v[32:35]
    v_mfma_f32_16x16x32_bf16 v[36:39], v[68:71], v[88:91], v[36:39]
    s_add_u32 m0, s62, 2112
    s_add_u32 s14, s60, 2048
    buffer_load_dwordx4 v6, s[48:51], s14 offen lds
    s_waitcnt lgkmcnt(2)
    v_mfma_f32_16x16x32_bf16 v[40:43], v[72:75], v[80:83], v[40:43]
    v_mfma_f32_16x16x32_bf16 v[44:47], v[72:75], v[84:87], v[44:47]
    v_mfma_f32_16x16x32_bf16 v[48:51], v[72:75], v[88:91], v[48:51]
    s_add_u32 m0, s62, 3168
    s_add_u32 s14, s60, 3072
    buffer_load_dwordx4 v6, s[48:51], s14 offen lds
    s_waitcnt lgkmcnt(0)
    v_mfma_f32_16x16x32_bf16 v[52:55], v[76:79], v[80:83], v[52:55]
    v_mfma_f32_16x16x32_bf16 v[56:59], v[76:79], v[84:87], v[56:59]
    v_mfma_f32_16x16x32_bf16 v[60:63], v[76:79], v[88:91], v[60:63]
    s_waitcnt vmcnt(4)
    s_barrier
    s_add_u32 s61, s5, 5
    s_and_b32 s61, s61, 15
    s_lshl_b32 s61, s61, 6
    v_add_u32 v7, s61, v11
    ds_read_b128 v[80:83], v7
    ds_read_b128 v[84:87], v7 offset:16896
    ds_read_b128 v[88:91], v7 offset:33792
    ds_read_b64_tr_b16 v[64:65], v10
    ds_read_b64_tr_b16 v[66:67], v10 offset:4224
    ds_read_b64_tr_b16 v[68:69], v10 offset:32
    ds_read_b64_tr_b16 v[70:71], v10 offset:4256
    ds_read_b64_tr_b16 v[72:73], v10 offset:64
    ds_read_b64_tr_b16 v[74:75], v10 offset:4288
    ds_read_b64_tr_b16 v[76:77], v10 offset:96
    ds_read_b64_tr_b16 v[78:79], v10 offset:4320
    s_add_u32 s60, s5, 7
    s_and_b32 s60, s60, 15
    s_mul_i32 s60, s60, 32768
    s_add_u32 s60, s60, s63
    s_add_u32 m0, s62, 34304
    s_add_u32 s14, s60, 0
    buffer_load_dwordx4 v6, s[48:51], s14 offen lds
    s_waitcnt lgkmcnt(6)
    v_mfma_f32_16x16x32_bf16 v[16:19], v[64:67], v[80:83], v[16:19]
    v_mfma_f32_16x16x32_bf16 v[20:23], v[64:67], v[84:87], v[20:23]
    v_mfma_f32_16x16x32_bf16 v[24:27], v[64:67], v[88:91], v[24:27]
    s_add_u32 m0, s62, 35360
    s_add_u32 s14, s60, 1024
    buffer_load_dwordx4 v6, s[48:51], s14 offen lds
    s_waitcnt lgkmcnt(4)
    v_mfma_f32_16x16x32_bf16 v[28:31], v[68:71], v[80:83], v[28:31]
    v_mfma_f32_16x16x32_bf16 v[32:35], v[68:71], v[84:87], v[32:35]
    v_mfma_f32_16x16x32_bf16 v[36:39], v[68:71], v[88:91], v[36:39]
    s_add_u32 m0, s62, 36416
    s_add_u32 s14, s60, 2048
    buffer_load_dwordx4 v6, s[48:51], s14 offen lds
    s_waitcnt lgkmcnt(2)
    v_mfma_f32_16x16x32_bf16 v[40:43], v[72:75], v[80:83], v[40:43]
    v_mfma_f32_16x16x32_bf16 v[44:47], v[72:75], v[84:87], v[44:47]
    v_mfma_f32_16x16x32_bf16 v[48:51], v[72:75], v[88:91], v[48:51]
    s_add_u32 m0, s62, 37472
    s_add_u32 s14, s60, 3072
    buffer_load_dwordx4 v6, s[48:51], s14 offen lds
    s_waitcnt lgkmcnt(0)
    v_mfma_f32_16x16x32_bf16 v[52:55], v[76:79], v[80:83], v[52:55]
    v_mfma_f32_16x16x32_bf16 v[56:59], v[76:79], v[84:87], v[56:59]
    v_mfma_f32_16x16x32_bf16 v[60:63], v[76:79], v[88:91], v[60:63]
    s_waitcnt vmcnt(4)
    s_barrier
    s_add_u32 s61, s5, 6
    s_and_b32 s61, s61, 15
    s_lshl_b32 s61, s61, 6
    v_add_u32 v7, s61, v11
    ds_read_b128 v[80:83], v7
    ds_read_b128 v[84:87], v7 offset:16896
    ds_read_b128 v[88:91], v7 offset:33792
    ds_read_b64_tr_b16 v[64:65], v8
    ds_read_b64_tr_b16 v[66:67], v8 offset:4224
    ds_read_b64_tr_b16 v[68:69], v8 offset:32
    ds_read_b64_tr_b16 v[70:71], v8 offset:4256
    ds_read_b64_tr_b16 v[72:73], v8 offset:64
    ds_read_b64_tr_b16 v[74:75], v8 offset:4288
    ds_read_b64_tr_b16 v[76:77], v8 offset:96
    ds_read_b64_tr_b16 v[78:79], v8 offset:4320
    s_add_u32 s60, s5, 8
    s_and_b32 s60, s60, 15
    s_mul_i32 s60, s60, 32768
    s_add_u32 s60, s60, s63
    s_add_u32 m0, s62, 68608
    s_add_u32 s14, s60, 0
    buffer_load_dwordx4 v6, s[48:51], s14 offen lds
    s_waitcnt lgkmcnt(6)
    v_mfma_f32_16x16x32_bf16 v[16:19], v[64:67], v[80:83], v[16:19]
    v_mfma_f32_16x16x32_bf16 v[20:23], v[64:67], v[84:87], v[20:23]
    v_mfma_f32_16x16x32_bf16 v[24:27], v[64:67], v[88:91], v[24:27]
    s_add_u32 m0, s62, 69664
    s_add_u32 s14, s60, 1024
    buffer_load_dwordx4 v6, s[48:51], s14 offen lds
    s_waitcnt lgkmcnt(4)
    v_mfma_f32_16x16x32_bf16 v[28:31], v[68:71], v[80:83], v[28:31]
    v_mfma_f32_16x16x32_bf16 v[32:35], v[68:71], v[84:87], v[32:35]
    v_mfma_f32_16x16x32_bf16 v[36:39], v[68:71], v[88:91], v[36:39]
    s_add_u32 m0, s62, 70720
    s_add_u32 s14, s60, 2048
    buffer_load_dwordx4 v6, s[48:51], s14 offen lds
    s_waitcnt lgkmcnt(2)
    v_mfma_f32_16x16x32_bf16 v[40:43], v[72:75], v[80:83], v[40:43]
    v_mfma_f32_16x16x32_bf16 v[44:47], v[72:75], v[84:87], v[44:47]
    v_mfma_f32_16x16x32_bf16 v[48:51], v[72:75], v[88:91], v[48:51]
    s_add_u32 m0, s62, 71776
    s_add_u32 s14, s60, 3072
    buffer_load_dwordx4 v6, s[48:51], s14 offen lds
    s_waitcnt lgkmcnt(0)
    v_mfma_f32_16x16x32_bf16 v[52:55], v[76:79], v[80:83], v[52:55]
    v_mfma_f32_16x16x32_bf16 v[56:59], v[76:79], v[84:87], v[56:59]
    v_mfma_f32_16x16x32_bf16 v[60:63], v[76:79], v[88:91], v[60:63]
    s_waitcnt vmcnt(4)
    s_barrier
    s_add_u32 s61, s5, 7
    s_and_b32 s61, s61, 15
    s_lshl_b32 s61, s61, 6
    v_add_u32 v7, s61, v11
    ds_read_b128 v[80:83], v7
    ds_read_b128 v[84:87], v7 offset:16896
    ds_read_b128 v[88:91], v7 offset:33792
    ds_read_b64_tr_b16 v[64:65], v9
    ds_read_b64_tr_b16 v[66:67], v9 offset:4224
    ds_read_b64_tr_b16 v[68:69], v9 offset:32
    ds_read_b64_tr_b16 v[70:71], v9 offset:4256
    ds_read_b64_tr_b16 v[72:73], v9 offset:64
    ds_read_b64_tr_b16 v[74:75], v9 offset:4288
    ds_read_b64_tr_b16 v[76:77], v9 offset:96
    ds_read_b64_tr_b16 v[78:79], v9 offset:4320
    s_add_u32 s60, s5, 9
    s_and_b32 s60, s60, 15
    s_mul_i32 s60, s60, 32768
    s_add_u32 s60, s60, s63
    s_add_u32 m0, s62, 0
    s_add_u32 s14, s60, 0
    buffer_load_dwordx4 v6, s[48:51], s14 offen lds
    s_waitcnt lgkmcnt(6)
    v_mfma_f32_16x16x32_bf16 v[16:19], v[64:67], v[80:83], v[16:19]
    v_mfma_f32_16x16x32_bf16 v[20:23], v[64:67], v[84:87], v[20:23]
    v_mfma_f32_16x16x32_bf16 v[24:27], v[64:67], v[88:91], v[24:27]
    s_add_u32 m0, s62, 1056
    s_add_u32 s14, s60, 1024
    buffer_load_dwordx4 v6, s[48:51], s14 offen lds
    s_waitcnt lgkmcnt(4)
    v_mfma_f32_16x16x32_bf16 v[28:31], v[68:71], v[80:83], v[28:31]
    v_mfma_f32_16x16x32_bf16 v[32:35], v[68:71], v[84:87], v[32:35]
    v_mfma_f32_16x16x32_bf16 v[36:39], v[68:71], v[88:91], v[36:39]
    s_add_u32 m0, s62, 2112
    s_add_u32 s14, s60, 2048
    buffer_load_dwordx4 v6, s[48:51], s14 offen lds
    s_waitcnt lgkmcnt(2)
    v_mfma_f32_16x16x32_bf16 v[40:43], v[72:75], v[80:83], v[40:43]
    v_mfma_f32_16x16x32_bf16 v[44:47], v[72:75], v[84:87], v[44:47]
    v_mfma_f32_16x16x32_bf16 v[48:51], v[72:75], v[88:91], v[48:51]
    s_add_u32 m0, s62, 3168
    s_add_u32 s14, s60, 3072
    buffer_load_dwordx4 v6, s[48:51], s14 offen lds
    s_waitcnt lgkmcnt(0)
    v_mfma_f32_16x16x32_bf16 v[52:55], v[76:79], v[80:83], v[52:55]
    v_mfma_f32_16x16x32_bf16 v[56:59], v[76:79], v[84:87], v[56:59]
    v_mfma_f32_16x16x32_bf16 v[60:63], v[76:79], v[88:91], v[60:63]
    s_waitcnt vmcnt(4)
    s_barrier
    s_add_u32 s61, s5, 8
    s_and_b32 s61, s61, 15
    s_lshl_b32 s61, s61, 6
    v_add_u32 v7, s61, v11
    ds_read_b128 v[80:83], v7
    ds_read_b128 v[84:87], v7 offset:16896
    ds_read_b128 v[88:91], v7 offset:33792
    ds_read_b64_tr_b16 v[64:65], v10
    ds_read_b64_tr_b16 v[66:67], v10 offset:4224
    ds_read_b64_tr_b16 v[68:69], v10 offset:32
    ds_read_b64_tr_b16 v[70:71], v10 offset:4256
    ds_read_b64_tr_b16 v[72:73], v10 offset:64
    ds_read_b64_tr_b16 v[74:75], v10 offset:4288
    ds_read_b64_tr_b16 v[76:77], v10 offset:96
    ds_read_b64_tr_b16 v[78:79], v10 offset:4320
    s_add_u32 s60, s5, 10
    s_and_b32 s60, s60, 15
    s_mul_i32 s60, s60, 32768
    s_add_u32 s60, s60, s63
    s_add_u32 m0, s62, 34304
    s_add_u32 s14, s60, 0
    buffer_load_dwordx4 v6, s[48:51], s14 offen lds
    s_waitcnt lgkmcnt(6)
    v_mfma_f32_16x16x32_bf16 v[16:19], v[64:67], v[80:83], v[16:19]
    v_mfma_f32_16x16x32_bf16 v[20:23], v[64:67], v[84:87], v[20:23]
    v_mfma_f32_16x16x32_bf16 v[24:27], v[64:67], v[88:91], v[24:27]
    s_add_u32 m0, s62, 35360
    s_add_u32 s14, s60, 1024
    buffer_load_dwordx4 v6, s[48:51], s14 offen lds
    s_waitcnt lgkmcnt(4)
    v_mfma_f32_16x16x32_bf16 v[28:31], v[68:71], v[80:83], v[28:31]
    v_mfma_f32_16x16x32_bf16 v[32:35], v[68:71], v[84:87], v[32:35]
    v_mfma_f32_16x16x32_bf16 v[36:39], v[68:71], v[88:91], v[36:39]
    s_add_u32 m0, s62, 36416
    s_add_u32 s14, s60, 2048
    buffer_load_dwordx4 v6, s[48:51], s14 offen lds
    s_waitcnt lgkmcnt(2)
    v_mfma_f32_16x16x32_bf16 v[40:43], v[72:75], v[80:83], v[40:43]
    v_mfma_f32_16x16x32_bf16 v[44:47], v[72:75], v[84:87], v[44:47]
    v_mfma_f32_16x16x32_bf16 v[48:51], v[72:75], v[88:91], v[48:51]
    s_add_u32 m0, s62, 37472
    s_add_u32 s14, s60, 3072
    buffer_load_dwordx4 v6, s[48:51], s14 offen lds
    s_waitcnt lgkmcnt(0)
    v_mfma_f32_16x16x32_bf16 v[52:55], v[76:79], v[80:83], v[52:55]
    v_mfma_f32_16x16x32_bf16 v[56:59], v[76:79], v[84:87], v[56:59]
    v_mfma_f32_16x16x32_bf16 v[60:63], v[76:79], v[88:91], v[60:63]
    s_waitcnt vmcnt(4)
    s_barrier
    s_add_u32 s61, s5, 9
    s_and_b32 s61, s61, 15
    s_lshl_b32 s61, s61, 6
    v_add_u32 v7, s61, v11
    ds_read_b128 v[80:83], v7
    ds_read_b128 v[84:87], v7 offset:16896
    ds_read_b128 v[88:91], v7 offset:33792
    ds_read_b64_tr_b16 v[64:65], v8
    ds_read_b64_tr_b16 v[66:67], v8 offset:4224
    ds_read_b64_tr_b16 v[68:69], v8 offset:32
    ds_read_b64_tr_b16 v[70:71], v8 offset:4256
    ds_read_b64_tr_b16 v[72:73], v8 offset:64
    ds_read_b64_tr_b16 v[74:75], v8 offset:4288
    ds_read_b64_tr_b16 v[76:77], v8 offset:96
    ds_read_b64_tr_b16 v[78:79], v8 offset:4320
    s_add_u32 s60, s5, 11
    s_and_b32 s60, s60, 15
    s_mul_i32 s60, s60, 32768
    s_add_u32 s60, s60, s63
    s_add_u32 m0, s62, 68608
    s_add_u32 s14, s60, 0
    buffer_load_dwordx4 v6, s[48:51], s14 offen lds
    s_waitcnt lgkmcnt(6)
    v_mfma_f32_16x16x32_bf16 v[16:19], v[64:67], v[80:83], v[16:19]
    v_mfma_f32_16x16x32_bf16 v[20:23], v[64:67], v[84:87], v[20:23]
    v_mfma_f32_16x16x32_bf16 v[24:27], v[64:67], v[88:91], v[24:27]
    s_add_u32 m0, s62, 69664
    s_add_u32 s14, s60, 1024
    buffer_load_dwordx4 v6, s[48:51], s14 offen lds
    s_waitcnt lgkmcnt(4)
    v_mfma_f32_16x16x32_bf16 v[28:31], v[68:71], v[80:83], v[28:31]
    v_mfma_f32_16x16x32_bf16 v[32:35], v[68:71], v[84:87], v[32:35]
    v_mfma_f32_16x16x32_bf16 v[36:39], v[68:71], v[88:91], v[36:39]
    s_add_u32 m0, s62, 70720
    s_add_u32 s14, s60, 2048
    buffer_load_dwordx4 v6, s[48:51], s14 offen lds
    s_waitcnt lgkmcnt(2)
    v_mfma_f32_16x16x32_bf16 v[40:43], v[72:75], v[80:83], v[40:43]
    v_mfma_f32_16x16x32_bf16 v[44:47], v[72:75], v[84:87], v[44:47]
    v_mfma_f32_16x16x32_bf16 v[48:51], v[72:75], v[88:91], v[48:51]
    s_add_u32 m0, s62, 71776
    s_add_u32 s14, s60, 3072
    buffer_load_dwordx4 v6, s[48:51], s14 offen lds
    s_waitcnt lgkmcnt(0)
    v_mfma_f32_16x16x32_bf16 v[52:55], v[76:79], v[80:83], v[52:55]
    v_mfma_f32_16x16x32_bf16 v[56:59], v[76:79], v[84:87], v[56:59]
    v_mfma_f32_16x16x32_bf16 v[60:63], v[76:79], v[88:91], v[60:63]
    s_waitcnt vmcnt(4)
    s_barrier
    s_add_u32 s61, s5, 10
    s_and_b32 s61, s61, 15
    s_lshl_b32 s61, s61, 6
    v_add_u32 v7, s61, v11
    ds_read_b128 v[80:83], v7
    ds_read_b128 v[84:87], v7 offset:16896
    ds_read_b128 v[88:91], v7 offset:33792
    ds_read_b64_tr_b16 v[64:65], v9
    ds_read_b64_tr_b16 v[66:67], v9 offset:4224
    ds_read_b64_tr_b16 v[68:69], v9 offset:32
    ds_read_b64_tr_b16 v[70:71], v9 offset:4256
    ds_read_b64_tr_b16 v[72:73], v9 offset:64
    ds_read_b64_tr_b16 v[74:75], v9 offset:4288
    ds_read_b64_tr_b16 v[76:77], v9 offset:96
    ds_read_b64_tr_b16 v[78:79], v9 offset:4320
    s_add_u32 s60, s5, 12
    s_and_b32 s60, s60, 15
    s_mul_i32 s60, s60, 32768
    s_add_u32 s60, s60, s63
    s_add_u32 m0, s62, 0
    s_add_u32 s14, s60, 0
    buffer_load_dwordx4 v6, s[48:51], s14 offen lds
    s_waitcnt lgkmcnt(6)
    v_mfma_f32_16x16x32_bf16 v[16:19], v[64:67], v[80:83], v[16:19]
    v_mfma_f32_16x16x32_bf16 v[20:23], v[64:67], v[84:87], v[20:23]
    v_mfma_f32_16x16x32_bf16 v[24:27], v[64:67], v[88:91], v[24:27]
    s_add_u32 m0, s62, 1056
    s_add_u32 s14, s60, 1024
    buffer_load_dwordx4 v6, s[48:51], s14 offen lds
    s_waitcnt lgkmcnt(4)
    v_mfma_f32_16x16x32_bf16 v[28:31], v[68:71], v[80:83], v[28:31]
    v_mfma_f32_16x16x32_bf16 v[32:35], v[68:71], v[84:87], v[32:35]
    v_mfma_f32_16x16x32_bf16 v[36:39], v[68:71], v[88:91], v[36:39]
    s_add_u32 m0, s62, 2112
    s_add_u32 s14, s60, 2048
    buffer_load_dwordx4 v6, s[48:51], s14 offen lds
    s_waitcnt lgkmcnt(2)
    v_mfma_f32_16x16x32_bf16 v[40:43], v[72:75], v[80:83], v[40:43]
    v_mfma_f32_16x16x32_bf16 v[44:47], v[72:75], v[84:87], v[44:47]
    v_mfma_f32_16x16x32_bf16 v[48:51], v[72:75], v[88:91], v[48:51]
    s_add_u32 m0, s62, 3168
    s_add_u32 s14, s60, 3072
    buffer_load_dwordx4 v6, s[48:51], s14 offen lds
    s_waitcnt lgkmcnt(0)
    v_mfma_f32_16x16x32_bf16 v[52:55], v[76:79], v[80:83], v[52:55]
    v_mfma_f32_16x16x32_bf16 v[56:59], v[76:79], v[84:87], v[56:59]
    v_mfma_f32_16x16x32_bf16 v[60:63], v[76:79], v[88:91], v[60:63]
    s_waitcnt vmcnt(4)
    s_barrier
    s_add_u32 s61, s5, 11
    s_and_b32 s61, s61, 15
    s_lshl_b32 s61, s61, 6
    v_add_u32 v7, s61, v11
    ds_read_b128 v[80:83], v7
    ds_read_b128 v[84:87], v7 offset:16896
    ds_read_b128 v[88:91], v7 offset:33792
    ds_read_b64_tr_b16 v[64:65], v10
    ds_read_b64_tr_b16 v[66:67], v10 offset:4224
    ds_read_b64_tr_b16 v[68:69], v10 offset:32
    ds_read_b64_tr_b16 v[70:71], v10 offset:4256
    ds_read_b64_tr_b16 v[72:73], v10 offset:64
    ds_read_b64_tr_b16 v[74:75], v10 offset:4288
    ds_read_b64_tr_b16 v[76:77], v10 offset:96
    ds_read_b64_tr_b16 v[78:79], v10 offset:4320
    s_add_u32 s60, s5, 13
    s_and_b32 s60, s60, 15
    s_mul_i32 s60, s60, 32768
    s_add_u32 s60, s60, s63
    s_add_u32 m0, s62, 34304
    s_add_u32 s14, s60, 0
    buffer_load_dwordx4 v6, s[48:51], s14 offen lds
    s_waitcnt lgkmcnt(6)
    v_mfma_f32_16x16x32_bf16 v[16:19], v[64:67], v[80:83], v[16:19]
    v_mfma_f32_16x16x32_bf16 v[20:23], v[64:67], v[84:87], v[20:23]
    v_mfma_f32_16x16x32_bf16 v[24:27], v[64:67], v[88:91], v[24:27]
    s_add_u32 m0, s62, 35360
    s_add_u32 s14, s60, 1024
    buffer_load_dwordx4 v6, s[48:51], s14 offen lds
    s_waitcnt lgkmcnt(4)
    v_mfma_f32_16x16x32_bf16 v[28:31], v[68:71], v[80:83], v[28:31]
    v_mfma_f32_16x16x32_bf16 v[32:35], v[68:71], v[84:87], v[32:35]
    v_mfma_f32_16x16x32_bf16 v[36:39], v[68:71], v[88:91], v[36:39]
    s_add_u32 m0, s62, 36416
    s_add_u32 s14, s60, 2048
    buffer_load_dwordx4 v6, s[48:51], s14 offen lds
    s_waitcnt lgkmcnt(2)
    v_mfma_f32_16x16x32_bf16 v[40:43], v[72:75], v[80:83], v[40:43]
    v_mfma_f32_16x16x32_bf16 v[44:47], v[72:75], v[84:87], v[44:47]
    v_mfma_f32_16x16x32_bf16 v[48:51], v[72:75], v[88:91], v[48:51]
    s_add_u32 m0, s62, 37472
    s_add_u32 s14, s60, 3072
    buffer_load_dwordx4 v6, s[48:51], s14 offen lds
    s_waitcnt lgkmcnt(0)
    v_mfma_f32_16x16x32_bf16 v[52:55], v[76:79], v[80:83], v[52:55]
    v_mfma_f32_16x16x32_bf16 v[56:59], v[76:79], v[84:87], v[56:59]
    v_mfma_f32_16x16x32_bf16 v[60:63], v[76:79], v[88:91], v[60:63]
    s_waitcnt vmcnt(4)
    s_barrier
    s_add_u32 s61, s5, 12
    s_and_b32 s61, s61, 15
    s_lshl_b32 s61, s61, 6
    v_add_u32 v7, s61, v11
    ds_read_b128 v[80:83], v7
    ds_read_b128 v[84:87], v7 offset:16896
    ds_read_b128 v[88:91], v7 offset:33792
    ds_read_b64_tr_b16 v[64:65], v8
    ds_read_b64_tr_b16 v[66:67], v8 offset:4224
    ds_read_b64_tr_b16 v[68:69], v8 offset:32
    ds_read_b64_tr_b16 v[70:71], v8 offset:4256
    ds_read_b64_tr_b16 v[72:73], v8 offset:64
    ds_read_b64_tr_b16 v[74:75], v8 offset:4288
    ds_read_b64_tr_b16 v[76:77], v8 offset:96
    ds_read_b64_tr_b16 v[78:79], v8 offset:4320
    s_add_u32 s60, s5, 14
    s_and_b32 s60, s60, 15
    s_mul_i32 s60, s60, 32768
    s_add_u32 s60, s60, s63
    s_add_u32 m0, s62, 68608
    s_add_u32 s14, s60, 0
    buffer_load_dwordx4 v6, s[48:51], s14 offen lds
    s_waitcnt lgkmcnt(6)
    v_mfma_f32_16x16x32_bf16 v[16:19], v[64:67], v[80:83], v[16:19]
    v_mfma_f32_16x16x32_bf16 v[20:23], v[64:67], v[84:87], v[20:23]
    v_mfma_f32_16x16x32_bf16 v[24:27], v[64:67], v[88:91], v[24:27]
    s_add_u32 m0, s62, 69664
    s_add_u32 s14, s60, 1024
    buffer_load_dwordx4 v6, s[48:51], s14 offen lds
    s_waitcnt lgkmcnt(4)
    v_mfma_f32_16x16x32_bf16 v[28:31], v[68:71], v[80:83], v[28:31]
    v_mfma_f32_16x16x32_bf16 v[32:35], v[68:71], v[84:87], v[32:35]
    v_mfma_f32_16x16x32_bf16 v[36:39], v[68:71], v[88:91], v[36:39]
    s_add_u32 m0, s62, 70720
    s_add_u32 s14, s60, 2048
    buffer_load_dwordx4 v6, s[48:51], s14 offen lds
    s_waitcnt lgkmcnt(2)
    v_mfma_f32_16x16x32_bf16 v[40:43], v[72:75], v[80:83], v[40:43]
    v_mfma_f32_16x16x32_bf16 v[44:47], v[72:75], v[84:87], v[44:47]
    v_mfma_f32_16x16x32_bf16 v[48:51], v[72:75], v[88:91], v[48:51]
    s_add_u32 m0, s62, 71776
    s_add_u32 s14, s60, 3072
    buffer_load_dwordx4 v6, s[48:51], s14 offen lds
    s_waitcnt lgkmcnt(0)
    v_mfma_f32_16x16x32_bf16 v[52:55], v[76:79], v[80:83], v[52:55]
    v_mfma_f32_16x16x32_bf16 v[56:59], v[76:79], v[84:87], v[56:59]
    v_mfma_f32_16x16x32_bf16 v[60:63], v[76:79], v[88:91], v[60:63]
    s_waitcnt vmcnt(4)
    s_barrier
    s_add_u32 s61, s5, 13
    s_and_b32 s61, s61, 15
    s_lshl_b32 s61, s61, 6
    v_add_u32 v7, s61, v11
    ds_read_b128 v[80:83], v7
    ds_read_b128 v[84:87], v7 offset:16896
    ds_read_b128 v[88:91], v7 offset:33792
    ds_read_b64_tr_b16 v[64:65], v9
    ds_read_b64_tr_b16 v[66:67], v9 offset:4224
    ds_read_b64_tr_b16 v[68:69], v9 offset:32
    ds_read_b64_tr_b16 v[70:71], v9 offset:4256
    ds_read_b64_tr_b16 v[72:73], v9 offset:64
    ds_read_b64_tr_b16 v[74:75], v9 offset:4288
    ds_read_b64_tr_b16 v[76:77], v9 offset:96
    ds_read_b64_tr_b16 v[78:79], v9 offset:4320
    s_add_u32 s60, s5, 15
    s_and_b32 s60, s60, 15
    s_mul_i32 s60, s60, 32768
    s_add_u32 s60, s60, s63
    s_add_u32 m0, s62, 0
    s_add_u32 s14, s60, 0
    buffer_load_dwordx4 v6, s[48:51], s14 offen lds
    s_waitcnt lgkmcnt(6)
    v_mfma_f32_16x16x32_bf16 v[16:19], v[64:67], v[80:83], v[16:19]
    v_mfma_f32_16x16x32_bf16 v[20:23], v[64:67], v[84:87], v[20:23]
    v_mfma_f32_16x16x32_bf16 v[24:27], v[64:67], v[88:91], v[24:27]
    s_add_u32 m0, s62, 1056
    s_add_u32 s14, s60, 1024
    buffer_load_dwordx4 v6, s[48:51], s14 offen lds
    s_waitcnt lgkmcnt(4)
    v_mfma_f32_16x16x32_bf16 v[28:31], v[68:71], v[80:83], v[28:31]
    v_mfma_f32_16x16x32_bf16 v[32:35], v[68:71], v[84:87], v[32:35]
    v_mfma_f32_16x16x32_bf16 v[36:39], v[68:71], v[88:91], v[36:39]
    s_add_u32 m0, s62, 2112
    s_add_u32 s14, s60, 2048
    buffer_load_dwordx4 v6, s[48:51], s14 offen lds
    s_waitcnt lgkmcnt(2)
    v_mfma_f32_16x16x32_bf16 v[40:43], v[72:75], v[80:83], v[40:43]
    v_mfma_f32_16x16x32_bf16 v[44:47], v[72:75], v[84:87], v[44:47]
    v_mfma_f32_16x16x32_bf16 v[48:51], v[72:75], v[88:91], v[48:51]
    s_add_u32 m0, s62, 3168
    s_add_u32 s14, s60, 3072
    buffer_load_dwordx4 v6, s[48:51], s14 offen lds
    s_waitcnt lgkmcnt(0)
    v_mfma_f32_16x16x32_bf16 v[52:55], v[76:79], v[80:83], v[52:55]
    v_mfma_f32_16x16x32_bf16 v[56:59], v[76:79], v[84:87], v[56:59]
    v_mfma_f32_16x16x32_bf16 v[60:63], v[76:79], v[88:91], v[60:63]
    s_waitcnt vmcnt(4)
    s_barrier
    s_add_u32 s61, s5, 14
    s_and_b32 s61, s61, 15
    s_lshl_b32 s61, s61, 6
    v_add_u32 v7, s61, v11
    ds_read_b128 v[80:83], v7
    ds_read_b128 v[84:87], v7 offset:16896
    ds_read_b128 v[88:91], v7 offset:33792
    ds_read_b64_tr_b16 v[64:65], v10
    ds_read_b64_tr_b16 v[66:67], v10 offset:4224
    ds_read_b64_tr_b16 v[68:69], v10 offset:32
    ds_read_b64_tr_b16 v[70:71], v10 offset:4256
    ds_read_b64_tr_b16 v[72:73], v10 offset:64
    ds_read_b64_tr_b16 v[74:75], v10 offset:4288
    ds_read_b64_tr_b16 v[76:77], v10 offset:96
    ds_read_b64_tr_b16 v[78:79], v10 offset:4320
    s_waitcnt lgkmcnt(6)
    v_mfma_f32_16x16x32_bf16 v[16:19], v[64:67], v[80:83], v[16:19]
    v_mfma_f32_16x16x32_bf16 v[20:23], v[64:67], v[84:87], v[20:23]
    v_mfma_f32_16x16x32_bf16 v[24:27], v[64:67], v[88:91], v[24:27]
    s_waitcnt lgkmcnt(4)
    v_mfma_f32_16x16x32_bf16 v[28:31], v[68:71], v[80:83], v[28:31]
    v_mfma_f32_16x16x32_bf16 v[32:35], v[68:71], v[84:87], v[32:35]
    v_mfma_f32_16x16x32_bf16 v[36:39], v[68:71], v[88:91], v[36:39]
    s_waitcnt lgkmcnt(2)
    v_mfma_f32_16x16x32_bf16 v[40:43], v[72:75], v[80:83], v[40:43]
    v_mfma_f32_16x16x32_bf16 v[44:47], v[72:75], v[84:87], v[44:47]
    v_mfma_f32_16x16x32_bf16 v[48:51], v[72:75], v[88:91], v[48:51]
    s_waitcnt lgkmcnt(0)
    v_mfma_f32_16x16x32_bf16 v[52:55], v[76:79], v[80:83], v[52:55]
    v_mfma_f32_16x16x32_bf16 v[56:59], v[76:79], v[84:87], v[56:59]
    v_mfma_f32_16x16x32_bf16 v[60:63], v[76:79], v[88:91], v[60:63]
    s_waitcnt vmcnt(0)
    s_barrier
    s_add_u32 s61, s5, 15
    s_and_b32 s61, s61, 15
    s_lshl_b32 s61, s61, 6
    v_add_u32 v7, s61, v11
    ds_read_b128 v[80:83], v7
    ds_read_b128 v[84:87], v7 offset:16896
    ds_read_b128 v[88:91], v7 offset:33792
    ds_read_b64_tr_b16 v[64:65], v8
    ds_read_b64_tr_b16 v[66:67], v8 offset:4224
    ds_read_b64_tr_b16 v[68:69], v8 offset:32
    ds_read_b64_tr_b16 v[70:71], v8 offset:4256
    ds_read_b64_tr_b16 v[72:73], v8 offset:64
    ds_read_b64_tr_b16 v[74:75], v8 offset:4288
    ds_read_b64_tr_b16 v[76:77], v8 offset:96
    ds_read_b64_tr_b16 v[78:79], v8 offset:4320
    s_waitcnt lgkmcnt(6)
    v_mfma_f32_16x16x32_bf16 v[16:19], v[64:67], v[80:83], v[16:19]
    v_mfma_f32_16x16x32_bf16 v[20:23], v[64:67], v[84:87], v[20:23]
    v_mfma_f32_16x16x32_bf16 v[24:27], v[64:67], v[88:91], v[24:27]
    s_waitcnt lgkmcnt(4)
    v_mfma_f32_16x16x32_bf16 v[28:31], v[68:71], v[80:83], v[28:31]
    v_mfma_f32_16x16x32_bf16 v[32:35], v[68:71], v[84:87], v[32:35]
    v_mfma_f32_16x16x32_bf16 v[36:39], v[68:71], v[88:91], v[36:39]
    s_waitcnt lgkmcnt(2)
    v_mfma_f32_16x16x32_bf16 v[40:43], v[72:75], v[80:83], v[40:43]
    v_mfma_f32_16x16x32_bf16 v[44:47], v[72:75], v[84:87], v[44:47]
    v_mfma_f32_16x16x32_bf16 v[48:51], v[72:75], v[88:91], v[48:51]
    s_waitcnt lgkmcnt(0)
    v_mfma_f32_16x16x32_bf16 v[52:55], v[76:79], v[80:83], v[52:55]
    v_mfma_f32_16x16x32_bf16 v[56:59], v[76:79], v[84:87], v[56:59]
    v_mfma_f32_16x16x32_bf16 v[60:63], v[76:79], v[88:91], v[60:63]
    s_mul_i32 s15, s2, 49152
    s_mul_i32 s14, s3, 6144
    s_add_u32 s15, s15, s14
    v_cvt_pk_bf16_f32 v64, v16, v17
    v_cvt_pk_bf16_f32 v65, v18, v19
    v_cvt_pk_bf16_f32 v66, v28, v29
    v_cvt_pk_bf16_f32 v67, v30, v31
    buffer_store_dwordx4 v[64:67], v6, s[56:59], s15 offen
    v_cvt_pk_bf16_f32 v68, v40, v41
    v_cvt_pk_bf16_f32 v69, v42, v43
    v_cvt_pk_bf16_f32 v70, v52, v53
    v_cvt_pk_bf16_f32 v71, v54, v55
    buffer_store_dwordx4 v[68:71], v6, s[56:59], s15 offen offset:1024
    v_cvt_pk_bf16_f32 v72, v20, v21
    v_cvt_pk_bf16_f32 v73, v22, v23
    v_cvt_pk_bf16_f32 v74, v32, v33
    v_cvt_pk_bf16_f32 v75, v34, v35
    buffer_store_dwordx4 v[72:75], v6, s[56:59], s15 offen offset:2048
    v_cvt_pk_bf16_f32 v76, v44, v45
    v_cvt_pk_bf16_f32 v77, v46, v47
    v_cvt_pk_bf16_f32 v78, v56, v57
    v_cvt_pk_bf16_f32 v79, v58, v59
    buffer_store_dwordx4 v[76:79], v6, s[56:59], s15 offen offset:3072
    v_cvt_pk_bf16_f32 v80, v24, v25
    v_cvt_pk_bf16_f32 v81, v26, v27
    v_cvt_pk_bf16_f32 v82, v36, v37
    v_cvt_pk_bf16_f32 v83, v38, v39
    s_add_u32 s14, s15, 4096
    buffer_store_dwordx4 v[80:83], v6, s[56:59], s14 offen
    v_cvt_pk_bf16_f32 v84, v48, v49
    v_cvt_pk_bf16_f32 v85, v50, v51
    v_cvt_pk_bf16_f32 v86, v60, v61
    v_cvt_pk_bf16_f32 v87, v62, v63
    s_add_u32 s14, s15, 5120
    buffer_store_dwordx4 v[84:87], v6, s[56:59], s14 offen
    s_waitcnt vmcnt(0)
L_end1:
    s_endpgm
.globl gqa_reduce_kernel
.p2align 8
.type gqa_reduce_kernel,@function
gqa_reduce_kernel:
    s_cmp_ge_u32 s2, 384
    s_cbranch_scc1 L_end2
    s_load_dwordx2 s[4:5], s[0:1], 80
    s_load_dwordx2 s[8:9], s[0:1], 96
    v_lshrrev_b32 v1, 6, v0
    v_and_b32 v2, 63, v0
    v_readfirstlane_b32 s3, v1
    s_mul_i32 s12, s2, 43691
    s_lshr_b32 s12, s12, 19
    s_mul_i32 s13, s12, 12
    s_sub_u32 s13, s2, s13
    s_lshl_b32 s13, s13, 2
    s_add_u32 s13, s13, s3
    s_mul_i32 s14, s13, 43
    s_lshr_b32 s14, s14, 8
    s_mul_i32 s15, s14, 6
    s_sub_u32 s15, s13, s15
    v_lshlrev_b32 v3, 4, v2
    s_mul_i32 s16, s12, 393216
    s_lshl_b32 s17, s13, 10
    s_add_u32 s16, s16, s17
    s_and_b32 s18, s12, 15
    s_mul_i32 s18, s18, 98304
    s_lshr_b32 s19, s12, 4
    s_lshl_b32 s19, s19, 10
    s_add_u32 s18, s18, s19
    s_lshl_b32 s19, s14, 7
    s_add_u32 s18, s18, s19
    s_lshr_b32 s19, s15, 1
    s_lshl_b32 s19, s19, 15
    s_add_u32 s18, s18, s19
    s_and_b32 s19, s15, 1
    s_lshl_b32 s19, s19, 6
    s_add_u32 s18, s18, s19
    v_and_b32 v4, 15, v2
    v_lshlrev_b32 v4, 11, v4
    v_lshrrev_b32 v5, 4, v2
    v_lshlrev_b32 v5, 3, v5
    v_add_u32 v4, v4, v5
    s_waitcnt lgkmcnt(0)
    s_mov_b32 s6, 1572864
    s_mov_b32 s7, 131072
    s_mov_b32 s10, 12582912
    s_mov_b32 s11, 131072
    s_add_u32 s20, s16, 0
    buffer_load_dwordx4 v[8:11], v3, s[8:11], s20 offen
    s_add_u32 s20, s16, 49152
    buffer_load_dwordx4 v[12:15], v3, s[8:11], s20 offen
    s_add_u32 s20, s16, 98304
    buffer_load_dwordx4 v[16:19], v3, s[8:11], s20 offen
    s_add_u32 s20, s16, 147456
    buffer_load_dwordx4 v[20:23], v3, s[8:11], s20 offen
    s_add_u32 s20, s16, 196608
    buffer_load_dwordx4 v[24:27], v3, s[8:11], s20 offen
    s_add_u32 s20, s16, 245760
    buffer_load_dwordx4 v[28:31], v3, s[8:11], s20 offen
    s_add_u32 s20, s16, 294912
    buffer_load_dwordx4 v[32:35], v3, s[8:11], s20 offen
    s_add_u32 s20, s16, 344064
    buffer_load_dwordx4 v[36:39], v3, s[8:11], s20 offen
    s_waitcnt vmcnt(7)
    v_lshlrev_b32 v40, 16, v8
    v_and_b32 v41, 4294901760, v8
    v_lshlrev_b32 v42, 16, v9
    v_and_b32 v43, 4294901760, v9
    v_lshlrev_b32 v44, 16, v10
    v_and_b32 v45, 4294901760, v10
    v_lshlrev_b32 v46, 16, v11
    v_and_b32 v47, 4294901760, v11
    s_waitcnt vmcnt(6)
    v_lshlrev_b32 v48, 16, v12
    v_and_b32 v49, 4294901760, v12
    v_add_f32 v40, v40, v48
    v_add_f32 v41, v41, v49
    v_lshlrev_b32 v48, 16, v13
    v_and_b32 v49, 4294901760, v13
    v_add_f32 v42, v42, v48
    v_add_f32 v43, v43, v49
    v_lshlrev_b32 v48, 16, v14
    v_and_b32 v49, 4294901760, v14
    v_add_f32 v44, v44, v48
    v_add_f32 v45, v45, v49
    v_lshlrev_b32 v48, 16, v15
    v_and_b32 v49, 4294901760, v15
    v_add_f32 v46, v46, v48
    v_add_f32 v47, v47, v49
    s_waitcnt vmcnt(5)
    v_lshlrev_b32 v48, 16, v16
    v_and_b32 v49, 4294901760, v16
    v_add_f32 v40, v40, v48
    v_add_f32 v41, v41, v49
    v_lshlrev_b32 v48, 16, v17
    v_and_b32 v49, 4294901760, v17
    v_add_f32 v42, v42, v48
    v_add_f32 v43, v43, v49
    v_lshlrev_b32 v48, 16, v18
    v_and_b32 v49, 4294901760, v18
    v_add_f32 v44, v44, v48
    v_add_f32 v45, v45, v49
    v_lshlrev_b32 v48, 16, v19
    v_and_b32 v49, 4294901760, v19
    v_add_f32 v46, v46, v48
    v_add_f32 v47, v47, v49
    s_waitcnt vmcnt(4)
    v_lshlrev_b32 v48, 16, v20
    v_and_b32 v49, 4294901760, v20
    v_add_f32 v40, v40, v48
    v_add_f32 v41, v41, v49
    v_lshlrev_b32 v48, 16, v21
    v_and_b32 v49, 4294901760, v21
    v_add_f32 v42, v42, v48
    v_add_f32 v43, v43, v49
    v_lshlrev_b32 v48, 16, v22
    v_and_b32 v49, 4294901760, v22
    v_add_f32 v44, v44, v48
    v_add_f32 v45, v45, v49
    v_lshlrev_b32 v48, 16, v23
    v_and_b32 v49, 4294901760, v23
    v_add_f32 v46, v46, v48
    v_add_f32 v47, v47, v49
    s_waitcnt vmcnt(3)
    v_lshlrev_b32 v48, 16, v24
    v_and_b32 v49, 4294901760, v24
    v_add_f32 v40, v40, v48
    v_add_f32 v41, v41, v49
    v_lshlrev_b32 v48, 16, v25
    v_and_b32 v49, 4294901760, v25
    v_add_f32 v42, v42, v48
    v_add_f32 v43, v43, v49
    v_lshlrev_b32 v48, 16, v26
    v_and_b32 v49, 4294901760, v26
    v_add_f32 v44, v44, v48
    v_add_f32 v45, v45, v49
    v_lshlrev_b32 v48, 16, v27
    v_and_b32 v49, 4294901760, v27
    v_add_f32 v46, v46, v48
    v_add_f32 v47, v47, v49
    s_waitcnt vmcnt(2)
    v_lshlrev_b32 v48, 16, v28
    v_and_b32 v49, 4294901760, v28
    v_add_f32 v40, v40, v48
    v_add_f32 v41, v41, v49
    v_lshlrev_b32 v48, 16, v29
    v_and_b32 v49, 4294901760, v29
    v_add_f32 v42, v42, v48
    v_add_f32 v43, v43, v49
    v_lshlrev_b32 v48, 16, v30
    v_and_b32 v49, 4294901760, v30
    v_add_f32 v44, v44, v48
    v_add_f32 v45, v45, v49
    v_lshlrev_b32 v48, 16, v31
    v_and_b32 v49, 4294901760, v31
    v_add_f32 v46, v46, v48
    v_add_f32 v47, v47, v49
    s_waitcnt vmcnt(1)
    v_lshlrev_b32 v48, 16, v32
    v_and_b32 v49, 4294901760, v32
    v_add_f32 v40, v40, v48
    v_add_f32 v41, v41, v49
    v_lshlrev_b32 v48, 16, v33
    v_and_b32 v49, 4294901760, v33
    v_add_f32 v42, v42, v48
    v_add_f32 v43, v43, v49
    v_lshlrev_b32 v48, 16, v34
    v_and_b32 v49, 4294901760, v34
    v_add_f32 v44, v44, v48
    v_add_f32 v45, v45, v49
    v_lshlrev_b32 v48, 16, v35
    v_and_b32 v49, 4294901760, v35
    v_add_f32 v46, v46, v48
    v_add_f32 v47, v47, v49
    s_waitcnt vmcnt(0)
    v_lshlrev_b32 v48, 16, v36
    v_and_b32 v49, 4294901760, v36
    v_add_f32 v40, v40, v48
    v_add_f32 v41, v41, v49
    v_lshlrev_b32 v48, 16, v37
    v_and_b32 v49, 4294901760, v37
    v_add_f32 v42, v42, v48
    v_add_f32 v43, v43, v49
    v_lshlrev_b32 v48, 16, v38
    v_and_b32 v49, 4294901760, v38
    v_add_f32 v44, v44, v48
    v_add_f32 v45, v45, v49
    v_lshlrev_b32 v48, 16, v39
    v_and_b32 v49, 4294901760, v39
    v_add_f32 v46, v46, v48
    v_add_f32 v47, v47, v49
    v_cvt_pk_bf16_f32 v50, v40, v41
    v_cvt_pk_bf16_f32 v51, v42, v43
    v_cvt_pk_bf16_f32 v52, v44, v45
    v_cvt_pk_bf16_f32 v53, v46, v47
    buffer_store_dwordx2 v[50:51], v4, s[4:7], s18 offen
    buffer_store_dwordx2 v[52:53], v4, s[4:7], s18 offen offset:32
L_end2:
    s_endpgm
.section .rodata,"a"
.p2align 6
.amdhsa_kernel concat_heads__gqa_block_cached__gqa_block_cached__near_ridge_kernel
  .amdhsa_next_free_vgpr 256
  .amdhsa_next_free_sgpr 102
  .amdhsa_accum_offset 256
  .amdhsa_group_segment_fixed_size 0
  .amdhsa_kernarg_size 104
  .amdhsa_user_sgpr_count 2
  .amdhsa_user_sgpr_kernarg_segment_ptr 1
  .amdhsa_system_sgpr_workgroup_id_x 1
.end_amdhsa_kernel
.p2align 6
.amdhsa_kernel gqa_reduce_kernel
  .amdhsa_next_free_vgpr 56
  .amdhsa_next_free_sgpr 102
  .amdhsa_accum_offset 56
  .amdhsa_group_segment_fixed_size 0
  .amdhsa_kernarg_size 104
  .amdhsa_user_sgpr_count 2
  .amdhsa_user_sgpr_kernarg_segment_ptr 1
  .amdhsa_system_sgpr_workgroup_id_x 1
.end_amdhsa_kernel
```
